```python
import torch

def _softmax(x, axis=-1):
    return torch.softmax(x, dim=axis)
def _gelu(x):
    return torch.nn.functional.gelu(x, approximate="tanh")
def _silu(x):
    return torch.nn.functional.silu(x)
def _sigmoid(x):
    return torch.sigmoid(x)
def _layernorm(x, axis=-1, eps=1e-5):
    m = x.mean(dim=axis, keepdim=True)
    v = x.var(dim=axis, keepdim=True, unbiased=False)
    return (x - m) / torch.sqrt(v + eps)
def _scatter_add(tgt, idx, src, axis=0):
    return tgt.clone().index_add_(axis, idx, src)
def _segment_sum(src, seg, n):
    out = torch.zeros((n,) + src.shape[1:], dtype=src.dtype)
    return out.index_add_(0, seg, src)
def _pad(x, pw):
    flat = tuple(v for pair in reversed(pw) for v in pair)
    return torch.nn.functional.pad(x, flat)

kernel_name = 'parallel_sum__sliding_block_cached__dense_activation_gelu__decode'

def setup_inputs():

    _w = (lambda a: (lambda t: t.to(torch.bfloat16) if t.is_floating_point() else t)(torch.as_tensor(a)))
    def _A_setup():
        B, Sq, D = 1, 1, 448
        Hq, Hkv, Sk, Dh = 16, 8, 8192, 256
        assert Hq % Hkv == 0, (Hq, Hkv)
        return {
            "x": _w((lambda *s: torch.randn(*s, dtype=torch.bfloat16) * 0.05)(B, Sq, D)),
            "k_cache": _w((lambda *s: torch.randn(*s, dtype=torch.bfloat16) * 1.6)(B, Hkv, Sk, Dh)),
            "v_cache": _w((lambda *s: torch.randn(*s, dtype=torch.bfloat16) * 0.4)(B, Hkv, Sk, Dh)),
            "wq": _w((lambda *s: torch.randn(*s, dtype=torch.bfloat16) * 1.6)(D, Hq * Dh) * (D ** -0.5)),
            "wo": _w((lambda *s: torch.randn(*s, dtype=torch.bfloat16) * 0.4)(Hq * Dh, D) * ((Hq * Dh) ** -0.5)),
        }
    _A_in = _A_setup()

    def _B_setup():
        B, S, D, F = 1, 1, 448, 1792
        return {
            "x": _w((lambda *s: torch.randn(*s, dtype=torch.bfloat16) * 0.05)(B, S, D)),
            "w1": _w((lambda *s: torch.randn(*s, dtype=torch.bfloat16) * 0.8)(D, F) * (D ** -0.5)),
            "b1": _w((lambda *s: torch.randn(*s, dtype=torch.bfloat16) * 12.8)(F) * 0.01),
            "w2": _w((lambda *s: torch.randn(*s, dtype=torch.bfloat16) * 0.2)(F, D) * (F ** -0.5)),
            "b2": _w((lambda *s: torch.randn(*s, dtype=torch.bfloat16) * 1.6)(D) * 0.01),
        }
    _B_in = _B_setup()

    return {
        "A_x": _A_in["x"],
        "A_k_cache": _A_in["k_cache"],
        "A_v_cache": _A_in["v_cache"],
        "A_wq": _A_in["wq"],
        "A_wo": _A_in["wo"],
        "B_x": _B_in["x"],
        "B_w1": _B_in["w1"],
        "B_b1": _B_in["b1"],
        "B_w2": _B_in["w2"],
        "B_b2": _B_in["b2"],
    }

def reference(A_x, A_k_cache, A_v_cache, A_wq, A_wo, B_x, B_w1, B_b1, B_w2, B_b2):
    def _A_ref(x, k_cache, v_cache, wq, wo):
        B, Sq, D = x.shape
        Hq, Dh = 16, 256
        Hkv, Sk = k_cache.shape[1], k_cache.shape[2]
        W = min(4096, max(256, Sk // 4))
        rep = Hq // Hkv
        q = (lambda x, *d: x.permute(*d))((x @ wq).reshape(B, Sq, Hq, Dh), 0, 2, 1, 3)
        k = (lambda x, n, axis: torch.repeat_interleave(x, n, dim=axis))(k_cache[:, :, Sk - W:, :], rep, axis=1)
        v = (lambda x, n, axis: torch.repeat_interleave(x, n, dim=axis))(v_cache[:, :, Sk - W:, :], rep, axis=1)
        scores = torch.einsum("bhqd,bhkd->bhqk", q, k) * (Dh ** -0.5)
        p = _softmax(scores, axis=-1)
        o = torch.einsum("bhqk,bhkd->bhqd", p, v)
        return (lambda x, *d: x.permute(*d))(o, 0, 2, 1, 3).reshape(B, Sq, Hq * Dh) @ wo

    def _B_ref(x, w1, b1, w2, b2):
        h = torch.einsum("bsd,df->bsf", x, w1) + b1
        h = _gelu(h)
        return torch.einsum("bsf,fd->bsd", h, w2) + b2

    x = A_x
    xn = _layernorm(x, axis=-1)
    return x + _A_ref(xn, A_k_cache, A_v_cache, A_wq, A_wo) + _B_ref(xn, B_w1, B_b1, B_w2, B_b2)
```

```asm
; @launch grid=(256,1,1) block=(320,1,1) lds=117760
.amdgcn_target "amdgcn-amd-amdhsa--gfx950"
.text
.globl parallel_sum__sliding_block_cached__dense_activation_gelu__decode_kernel
.p2align 12
.fill 832, 4, 0xbf800000
.type parallel_sum__sliding_block_cached__dense_activation_gelu__decode_kernel,@function
parallel_sum__sliding_block_cached__dense_activation_gelu__decode_kernel:
    s_load_dwordx16 s[4:19], s[0:1], 0
    s_load_dwordx8 s[20:27], s[0:1], 64
    s_load_dwordx2 s[28:29], s[0:1], 96
    s_cmp_ge_u32 s2, 256
    s_cbranch_scc1 L_end
    v_lshrrev_b32 v1, 6, v0
    v_and_b32 v0, 63, v0
    v_readfirstlane_b32 s3, v1
    s_and_b32 s30, s2, 7
    s_lshr_b32 s31, s2, 3
    v_lshrrev_b32 v2, 4, v0
    v_and_b32 v5, 7, v0
    v_lshrrev_b32 v7, 3, v0
    s_lshr_b32 s33, s31, 2
    s_and_b32 s32, s31, 3
    s_lshl2_add_u32 s44, s30, s32
    s_max_u32 s43, s44, 4
    s_sub_u32 s43, s43, 4
    s_cmp_lt_u32 s31, 28
    s_cselect_b32 s63, s30, 0
    s_cmp_eq_u32 s3, 0
    s_cbranch_scc1 L_loader
    s_getpc_b64 s[40:41]
    s_mul_i32 s34, s31, 384
    v_lshl_add_u32 v3, v5, 6, s34
    global_load_dword v148, v3, s[40:41] offset:704
    v_lshlrev_b32 v3, 4, v0
    v_mov_b32 v140, 0
    v_mov_b32 v141, 0
    v_mov_b32 v142, 0
    v_mov_b32 v143, 0
    s_bfm_b64 exec, 56, 0
    s_waitcnt lgkmcnt(0)
    global_load_dwordx4 v[140:143], v3, s[4:5]
    s_load_dword s38, s[28:29], 0
    s_mov_b64 exec, -1
    s_branch L_comp
L_loader:
    v_lshlrev_b32 v6, 1, v2
    v_xor_b32 v6, v5, v6
    v_lshlrev_b32 v6, 4, v6
    s_mul_i32 s34, s32, 917504
    s_lshl_b32 s35, s30, 10
    s_add_u32 s34, s34, s35
    s_xor_b32 s35, s33, 4
    s_lshl_b32 s35, s35, 7
    s_add_u32 s34, s34, s35
    v_lshl_add_u32 v8, v7, 13, s34
    v_add_u32 v8, v8, v6
    s_mul_i32 s34, s30, 4194304
    s_lshr_b32 s35, s31, 3
    s_lshl_b32 s35, s35, 15
    s_add_u32 s34, s34, s35
    s_and_b32 s35, s31, 7
    s_lshl_b32 s35, s35, 9
    s_add_u32 s34, s34, s35
    s_add_u32 s34, s34, 0x300000
    s_movk_i32 s35, 4608
    v_mad_u32_u24 v4, v7, s35, v6
    v_xor_b32 v4, s34, v4
    s_mov_b32 s37, 64512
    s_mul_i32 s34, s33, 229376
    s_lshl_b32 s35, s43, 7
    s_add_u32 s34, s34, s35
    s_movk_i32 s35, 3584
    v_mad_u32_u24 v14, v7, s35, v6
    v_add_u32 v14, s34, v14
    s_movk_i32 s36, 27648
    s_movk_i32 s46, -896
    v_mov_b32 v3, v4
    s_movk_i32 m0, 8192
    s_waitcnt lgkmcnt(0)
    global_load_lds_dwordx4 v8, s[10:11] offset:0
    v_add_u32 v8, s37, v8
    global_load_lds_dwordx4 v8, s[10:11] offset:1024
    v_add_u32 v8, s37, v8
    global_load_lds_dwordx4 v8, s[10:11] offset:2048
    v_add_u32 v8, s37, v8
    global_load_lds_dwordx4 v8, s[10:11] offset:3072
    s_addk_i32 m0, 4096
    v_add_u32 v8, 68608, v8
    global_load_lds_dwordx4 v8, s[10:11] offset:0
    v_add_u32 v8, s37, v8
    global_load_lds_dwordx4 v8, s[10:11] offset:1024
    v_add_u32 v8, s37, v8
    global_load_lds_dwordx4 v8, s[10:11] offset:2048
    v_add_u32 v8, s37, v8
    global_load_lds_dwordx4 v8, s[10:11] offset:3072
    s_addk_i32 m0, 4096
    v_add_u32 v8, 68608, v8
    global_load_lds_dwordx4 v8, s[10:11] offset:0
    v_add_u32 v8, s37, v8
    global_load_lds_dwordx4 v8, s[10:11] offset:1024
    v_add_u32 v8, s37, v8
    global_load_lds_dwordx4 v8, s[10:11] offset:2048
    v_add_u32 v8, s37, v8
    global_load_lds_dwordx4 v8, s[10:11] offset:3072
    s_addk_i32 m0, 4096
    v_add_u32 v8, 68608, v8
    global_load_lds_dwordx4 v8, s[10:11] offset:0
    v_add_u32 v8, s37, v8
    global_load_lds_dwordx4 v8, s[10:11] offset:1024
    s_movk_i32 m0, 0
    s_cmp_eq_u32 s63, 0
    s_cbranch_scc1 L_k0
    global_load_lds_dwordx4 v14, s[16:17] offset:0
    v_add_u32 v14, s36, v14
    global_load_lds_dwordx4 v14, s[16:17] offset:1024
    v_add_u32 v14, s36, v14
    global_load_lds_dwordx4 v14, s[16:17] offset:2048
    v_add_u32 v14, s36, v14
    global_load_lds_dwordx4 v14, s[16:17] offset:3072
    s_addk_i32 m0, 4096
    v_add_u32 v14, 31744, v14
    global_load_lds_dwordx4 v14, s[16:17] offset:0
    v_add_u32 v14, s36, v14
    global_load_lds_dwordx4 v14, s[16:17] offset:1024
    v_add_u32 v14, s36, v14
    global_load_lds_dwordx4 v14, s[16:17] offset:2048
    v_add_u32 v14, s36, v14
    global_load_lds_dwordx4 v14, s[16:17] offset:3072
L_k0:
    s_mov_b32 m0, 50176
    s_nop 0
    global_load_lds_dwordx4 v3, s[6:7] offset:0
    v_add_u32 v3, s46, v3
    global_load_lds_dwordx4 v3, s[6:7] offset:1024
    v_add_u32 v3, s46, v3
    s_cmp_eq_u32 s63, 0
    s_cbranch_scc0 L_k1
    global_load_lds_dwordx4 v3, s[6:7] offset:2048
    v_add_u32 v3, s46, v3
    global_load_lds_dwordx4 v3, s[6:7] offset:3072
    s_addk_i32 m0, 4096
    v_xor_b32 v3, 0x20000, v4
    global_load_lds_dwordx4 v3, s[6:7] offset:0
    v_add_u32 v3, s46, v3
    global_load_lds_dwordx4 v3, s[6:7] offset:1024
    v_add_u32 v3, s46, v3
    global_load_lds_dwordx4 v3, s[6:7] offset:2048
    v_add_u32 v3, s46, v3
    global_load_lds_dwordx4 v3, s[6:7] offset:3072
    s_addk_i32 m0, 4096
    v_xor_b32 v3, 0x40000, v4
    s_cmp_eq_u32 s30, 0
    s_cbranch_scc0 L_k1
    global_load_lds_dwordx4 v3, s[6:7] offset:0
    v_add_u32 v3, s46, v3
    global_load_lds_dwordx4 v3, s[6:7] offset:1024
    v_add_u32 v3, s46, v3
L_k1:
    s_load_dword s38, s[28:29], 0
    s_lshl_b32 s35, s33, 7
    v_mul_u32_u24 v9, 896, v7
    v_add3_u32 v9, v9, v6, s35
    s_mul_i32 s34, s43, 57344
    v_lshrrev_b32 v8, 5, v0
    v_mul_u32_u24 v8, 10752, v8
    v_add3_u32 v8, v8, v9, s34
    s_lshr_b32 s34, s44, 1
    s_lshl_b32 s34, s34, 3
    s_and_b32 s35, s32, 1
    s_add_u32 s34, s34, s35
    s_mul_i32 s34, s34, 28672
    v_add_u32 v9, s34, v9
    v_xor_b32 v10, 0x80000, v4
    v_xor_b32 v11, 0xa0000, v4
    v_xor_b32 v12, 0xc0000, v4
    v_xor_b32 v13, 0xe0000, v4
    s_lshl_b32 s34, s43, 11
    s_add_u32 s34, s34, 131072
    v_lshl_add_u32 v15, v0, 4, s34
    s_cmp_eq_u32 s63, 0
    s_cbranch_scc0 L_loadF
    s_cmp_eq_u32 s30, 0
    s_cbranch_scc0 L_loadN
    global_load_lds_dwordx4 v3, s[6:7] offset:2048
    v_add_u32 v3, s46, v3
    global_load_lds_dwordx4 v3, s[6:7] offset:3072
    s_addk_i32 m0, 4096
    v_xor_b32 v3, 0x60000, v4
    global_load_lds_dwordx4 v3, s[6:7] offset:0
    v_add_u32 v3, s46, v3
    s_waitcnt vmcnt(26)
    global_load_lds_dwordx4 v3, s[6:7] offset:1024
    v_add_u32 v3, s46, v3
    s_waitcnt vmcnt(26)
    global_load_lds_dwordx4 v3, s[6:7] offset:2048
    v_add_u32 v3, s46, v3
    s_waitcnt vmcnt(26)
    global_load_lds_dwordx4 v3, s[6:7] offset:3072
    s_addk_i32 m0, 4096
    v_xor_b32 v3, 0x80000, v4
    s_waitcnt vmcnt(26)
    global_load_lds_dwordx4 v3, s[6:7] offset:0
    v_add_u32 v3, s46, v3
    s_waitcnt vmcnt(26)
    global_load_lds_dwordx4 v3, s[6:7] offset:1024
    v_add_u32 v3, s46, v3
    s_waitcnt vmcnt(26)
    global_load_lds_dwordx4 v3, s[6:7] offset:2048
    v_add_u32 v3, s46, v3
    s_waitcnt vmcnt(26)
    global_load_lds_dwordx4 v3, s[6:7] offset:3072
    s_addk_i32 m0, 4096
    v_xor_b32 v3, 0xa0000, v4
    s_waitcnt vmcnt(26)
    global_load_lds_dwordx4 v3, s[6:7] offset:0
    v_add_u32 v3, s46, v3
    s_waitcnt vmcnt(26)
    global_load_lds_dwordx4 v3, s[6:7] offset:1024
    v_add_u32 v3, s46, v3
    s_waitcnt vmcnt(22)
    s_barrier
    s_barrier
    global_load_lds_dwordx4 v3, s[6:7] offset:2048
    v_add_u32 v3, s46, v3
    global_load_lds_dwordx4 v3, s[6:7] offset:3072
    s_addk_i32 m0, 4096
    v_xor_b32 v3, 0xc0000, v4
    global_load_lds_dwordx4 v3, s[6:7] offset:0
    v_add_u32 v3, s46, v3
    global_load_lds_dwordx4 v3, s[6:7] offset:1024
    v_add_u32 v3, s46, v3
    global_load_lds_dwordx4 v3, s[6:7] offset:2048
    v_add_u32 v3, s46, v3
    s_waitcnt vmcnt(26)
    global_load_lds_dwordx4 v3, s[6:7] offset:3072
    s_addk_i32 m0, 4096
    v_xor_b32 v3, 0xe0000, v4
    s_waitcnt vmcnt(26)
    global_load_lds_dwordx4 v3, s[6:7] offset:0
    v_add_u32 v3, s46, v3
    s_waitcnt vmcnt(26)
    global_load_lds_dwordx4 v3, s[6:7] offset:1024
    v_add_u32 v3, s46, v3
    s_waitcnt vmcnt(26)
    global_load_lds_dwordx4 v3, s[6:7] offset:2048
    v_add_u32 v3, s46, v3
    s_waitcnt vmcnt(26)
    global_load_lds_dwordx4 v3, s[6:7] offset:3072
    s_addk_i32 m0, 4096
    v_mov_b32 v3, v4
    s_waitcnt vmcnt(26)
    global_load_lds_dwordx4 v3, s[8:9] offset:0
    v_add_u32 v3, s46, v3
    s_waitcnt vmcnt(26)
    global_load_lds_dwordx4 v3, s[8:9] offset:1024
    v_add_u32 v3, s46, v3
    s_waitcnt vmcnt(26)
    global_load_lds_dwordx4 v3, s[8:9] offset:2048
    v_add_u32 v3, s46, v3
    s_waitcnt vmcnt(26)
    global_load_lds_dwordx4 v3, s[8:9] offset:3072
    s_addk_i32 m0, 4096
    v_xor_b32 v3, 0x20000, v4
    s_waitcnt vmcnt(26)
    global_load_lds_dwordx4 v3, s[8:9] offset:0
    v_add_u32 v3, s46, v3
    s_waitcnt vmcnt(26)
    global_load_lds_dwordx4 v3, s[8:9] offset:1024
    v_add_u32 v3, s46, v3
    s_waitcnt vmcnt(26)
    global_load_lds_dwordx4 v3, s[8:9] offset:2048
    v_add_u32 v3, s46, v3
    s_waitcnt vmcnt(26)
    global_load_lds_dwordx4 v3, s[8:9] offset:3072
    s_addk_i32 m0, 4096
    v_xor_b32 v3, 0x40000, v4
    s_waitcnt vmcnt(26)
    global_load_lds_dwordx4 v3, s[8:9] offset:0
    v_add_u32 v3, s46, v3
    s_waitcnt vmcnt(26)
    global_load_lds_dwordx4 v3, s[8:9] offset:1024
    v_add_u32 v3, s46, v3
    s_barrier
    s_waitcnt vmcnt(24)
    global_load_lds_dwordx4 v3, s[8:9] offset:2048
    v_add_u32 v3, s46, v3
    s_waitcnt vmcnt(24)
    global_load_lds_dwordx4 v3, s[8:9] offset:3072
    s_addk_i32 m0, 4096
    v_xor_b32 v3, 0x60000, v4
    s_waitcnt vmcnt(24)
    global_load_lds_dwordx4 v3, s[8:9] offset:0
    v_add_u32 v3, s46, v3
    s_waitcnt vmcnt(24)
    global_load_lds_dwordx4 v3, s[8:9] offset:1024
    v_add_u32 v3, s46, v3
    s_waitcnt vmcnt(24)
    global_load_lds_dwordx4 v3, s[8:9] offset:2048
    v_add_u32 v3, s46, v3
    s_waitcnt vmcnt(24)
    global_load_lds_dwordx4 v3, s[8:9] offset:3072
    s_addk_i32 m0, 4096
    s_waitcnt vmcnt(24)
    global_load_lds_dwordx4 v10, s[8:9] offset:0
    s_addk_i32 m0, 4096
    s_waitcnt vmcnt(24)
    global_load_lds_dwordx4 v11, s[8:9] offset:0
    s_addk_i32 m0, 4096
    s_waitcnt vmcnt(24)
    global_load_lds_dwordx4 v12, s[8:9] offset:0
    s_addk_i32 m0, 4096
    s_waitcnt vmcnt(24)
    global_load_lds_dwordx4 v13, s[8:9] offset:0
    s_addk_i32 m0, -11392
    s_waitcnt vmcnt(24)
    global_load_lds_dwordx4 v10, s[8:9] offset:128
    s_addk_i32 m0, 4096
    s_waitcnt vmcnt(24)
    global_load_lds_dwordx4 v11, s[8:9] offset:128
    s_addk_i32 m0, 4096
    s_waitcnt vmcnt(24)
    global_load_lds_dwordx4 v12, s[8:9] offset:128
    s_addk_i32 m0, 4096
    s_waitcnt vmcnt(24)
    global_load_lds_dwordx4 v13, s[8:9] offset:128
    s_addk_i32 m0, -11392
    s_waitcnt vmcnt(24)
    global_load_lds_dwordx4 v10, s[8:9] offset:256
    s_addk_i32 m0, 4096
    s_barrier
    s_waitcnt vmcnt(24)
    global_load_lds_dwordx4 v11, s[8:9] offset:256
    s_addk_i32 m0, 4096
    s_waitcnt vmcnt(24)
    global_load_lds_dwordx4 v12, s[8:9] offset:256
    s_addk_i32 m0, 4096
    s_waitcnt vmcnt(24)
    global_load_lds_dwordx4 v13, s[8:9] offset:256
    s_addk_i32 m0, -11392
    s_waitcnt vmcnt(24)
    global_load_lds_dwordx4 v10, s[8:9] offset:384
    s_addk_i32 m0, 4096
    s_waitcnt vmcnt(24)
    global_load_lds_dwordx4 v11, s[8:9] offset:384
    s_addk_i32 m0, 4096
    s_waitcnt vmcnt(24)
    global_load_lds_dwordx4 v12, s[8:9] offset:384
    s_addk_i32 m0, 4096
    s_waitcnt vmcnt(24)
    global_load_lds_dwordx4 v13, s[8:9] offset:384
    s_mov_b32 m0, 33792
    s_cmp_lt_u32 s31, 28
    s_cbranch_scc0 L_cloadZ
    s_waitcnt vmcnt(24)
    global_load_lds_dwordx4 v9, s[12:13] offset:0
    v_add_u32 v9, 0x1800, v9
    s_waitcnt vmcnt(24)
    global_load_lds_dwordx4 v9, s[12:13] offset:1024
    v_add_u32 v9, 0xc000, v9
    s_waitcnt vmcnt(24)
    global_load_lds_dwordx4 v9, s[12:13] offset:2048
    v_add_u32 v9, 0x1800, v9
    global_load_lds_dwordx4 v9, s[12:13] offset:3072
    s_addk_i32 m0, 4096
    v_add_u32 v9, 0xd000, v9
    global_load_lds_dwordx4 v9, s[12:13] offset:0
    v_add_u32 v9, 0x1800, v9
    s_barrier
    global_load_lds_dwordx4 v9, s[12:13] offset:1024
    v_add_u32 v9, 0xc000, v9
    global_load_lds_dwordx4 v9, s[12:13] offset:2048
    v_add_u32 v9, 0x1800, v9
    global_load_lds_dwordx4 v9, s[12:13] offset:3072
    s_addk_i32 m0, 4096
    v_add_u32 v9, 0xfffd8800, v9
    s_barrier
    s_waitcnt vmcnt(24)
    s_barrier
    s_waitcnt vmcnt(12)
    s_barrier
    s_waitcnt vmcnt(8)
    s_barrier
    s_barrier
    global_load_lds_dwordx4 v9, s[12:13] offset:0
    v_add_u32 v9, 0x1800, v9
    global_load_lds_dwordx4 v9, s[12:13] offset:1024
    v_add_u32 v9, 0xc000, v9
    global_load_lds_dwordx4 v9, s[12:13] offset:2048
    v_add_u32 v9, 0x1800, v9
    global_load_lds_dwordx4 v9, s[12:13] offset:3072
    s_addk_i32 m0, 4096
    v_add_u32 v9, 0xd000, v9
    global_load_lds_dwordx4 v9, s[12:13] offset:0
    v_add_u32 v9, 0x1800, v9
    global_load_lds_dwordx4 v9, s[12:13] offset:1024
    v_add_u32 v9, 0xc000, v9
    global_load_lds_dwordx4 v9, s[12:13] offset:2048
    v_add_u32 v9, 0x1800, v9
    global_load_lds_dwordx4 v9, s[12:13] offset:3072
    s_waitcnt vmcnt(4)
    s_barrier
    s_waitcnt vmcnt(0)
    s_barrier
    s_endpgm
L_cloadZ:
    s_waitcnt vmcnt(22)
    s_barrier
    s_barrier
    s_waitcnt vmcnt(16)
    s_barrier
    s_waitcnt vmcnt(4)
    s_barrier
    s_waitcnt vmcnt(0)
    s_barrier
    s_barrier
    s_endpgm
L_loadF:
    s_waitcnt vmcnt(23)
    global_load_lds_dwordx4 v3, s[6:7] offset:2048
    v_add_u32 v3, s46, v3
    s_waitcnt vmcnt(23)
    global_load_lds_dwordx4 v3, s[6:7] offset:3072
    s_addk_i32 m0, 4096
    v_xor_b32 v3, 0x20000, v4
    s_waitcnt vmcnt(23)
    global_load_lds_dwordx4 v3, s[6:7] offset:0
    v_add_u32 v3, s46, v3
    s_waitcnt vmcnt(23)
    global_load_lds_dwordx4 v3, s[6:7] offset:1024
    v_add_u32 v3, s46, v3
    s_waitcnt vmcnt(23)
    global_load_lds_dwordx4 v3, s[6:7] offset:2048
    v_add_u32 v3, s46, v3
    s_waitcnt vmcnt(23)
    global_load_lds_dwordx4 v3, s[6:7] offset:3072
    s_addk_i32 m0, 4096
    v_xor_b32 v3, 0x40000, v4
    s_waitcnt vmcnt(23)
    global_load_lds_dwordx4 v3, s[6:7] offset:0
    v_add_u32 v3, s46, v3
    s_waitcnt vmcnt(23)
    global_load_lds_dwordx4 v3, s[6:7] offset:1024
    v_add_u32 v3, s46, v3
    s_waitcnt vmcnt(23)
    global_load_lds_dwordx4 v3, s[6:7] offset:2048
    v_add_u32 v3, s46, v3
    s_waitcnt vmcnt(23)
    global_load_lds_dwordx4 v3, s[6:7] offset:3072
    s_addk_i32 m0, 4096
    v_xor_b32 v3, 0x60000, v4
    s_waitcnt vmcnt(23)
    global_load_lds_dwordx4 v3, s[6:7] offset:0
    v_add_u32 v3, s46, v3
    s_waitcnt vmcnt(23)
    global_load_lds_dwordx4 v3, s[6:7] offset:1024
    v_add_u32 v3, s46, v3
    s_waitcnt vmcnt(23)
    global_load_lds_dwordx4 v3, s[6:7] offset:2048
    v_add_u32 v3, s46, v3
    s_waitcnt vmcnt(23)
    global_load_lds_dwordx4 v3, s[6:7] offset:3072
    s_addk_i32 m0, 4096
    v_xor_b32 v3, 0x80000, v4
    s_barrier
    s_barrier
    s_waitcnt vmcnt(23)
    global_load_lds_dwordx4 v3, s[6:7] offset:0
    v_add_u32 v3, s46, v3
    s_waitcnt vmcnt(23)
    global_load_lds_dwordx4 v3, s[6:7] offset:1024
    v_add_u32 v3, s46, v3
    s_waitcnt vmcnt(23)
    global_load_lds_dwordx4 v3, s[6:7] offset:2048
    v_add_u32 v3, s46, v3
    s_waitcnt vmcnt(23)
    global_load_lds_dwordx4 v3, s[6:7] offset:3072
    s_addk_i32 m0, 4096
    v_xor_b32 v3, 0xa0000, v4
    s_waitcnt vmcnt(23)
    global_load_lds_dwordx4 v3, s[6:7] offset:0
    v_add_u32 v3, s46, v3
    s_waitcnt vmcnt(23)
    global_load_lds_dwordx4 v3, s[6:7] offset:1024
    v_add_u32 v3, s46, v3
    s_waitcnt vmcnt(23)
    global_load_lds_dwordx4 v3, s[6:7] offset:2048
    v_add_u32 v3, s46, v3
    s_waitcnt vmcnt(23)
    global_load_lds_dwordx4 v3, s[6:7] offset:3072
    s_addk_i32 m0, 4096
    v_xor_b32 v3, 0xc0000, v4
    s_barrier
    s_waitcnt vmcnt(23)
    global_load_lds_dwordx4 v3, s[6:7] offset:0
    v_add_u32 v3, s46, v3
    s_waitcnt vmcnt(23)
    global_load_lds_dwordx4 v3, s[6:7] offset:1024
    v_add_u32 v3, s46, v3
    s_waitcnt vmcnt(23)
    global_load_lds_dwordx4 v3, s[6:7] offset:2048
    v_add_u32 v3, s46, v3
    s_waitcnt vmcnt(23)
    global_load_lds_dwordx4 v3, s[6:7] offset:3072
    s_addk_i32 m0, 4096
    v_xor_b32 v3, 0xe0000, v4
    s_waitcnt vmcnt(23)
    global_load_lds_dwordx4 v3, s[6:7] offset:0
    v_add_u32 v3, s46, v3
    s_waitcnt vmcnt(23)
    global_load_lds_dwordx4 v3, s[6:7] offset:1024
    v_add_u32 v3, s46, v3
    s_waitcnt vmcnt(23)
    global_load_lds_dwordx4 v3, s[6:7] offset:2048
    v_add_u32 v3, s46, v3
    s_waitcnt vmcnt(23)
    global_load_lds_dwordx4 v3, s[6:7] offset:3072
    s_addk_i32 m0, 4096
    v_mov_b32 v3, v4
    s_waitcnt vmcnt(23)
    global_load_lds_dwordx4 v3, s[8:9] offset:0
    v_add_u32 v3, s46, v3
    s_waitcnt vmcnt(23)
    global_load_lds_dwordx4 v3, s[8:9] offset:1024
    v_add_u32 v3, s46, v3
    s_waitcnt vmcnt(23)
    global_load_lds_dwordx4 v3, s[8:9] offset:2048
    v_add_u32 v3, s46, v3
    s_waitcnt vmcnt(23)
    global_load_lds_dwordx4 v3, s[8:9] offset:3072
    s_addk_i32 m0, 4096
    v_xor_b32 v3, 0x20000, v4
    s_waitcnt vmcnt(23)
    global_load_lds_dwordx4 v3, s[8:9] offset:0
    v_add_u32 v3, s46, v3
    s_waitcnt vmcnt(23)
    global_load_lds_dwordx4 v3, s[8:9] offset:1024
    v_add_u32 v3, s46, v3
    s_waitcnt vmcnt(23)
    global_load_lds_dwordx4 v3, s[8:9] offset:2048
    v_add_u32 v3, s46, v3
    s_barrier
    s_waitcnt vmcnt(23)
    global_load_lds_dwordx4 v3, s[8:9] offset:3072
    s_addk_i32 m0, 4096
    v_xor_b32 v3, 0x40000, v4
    s_waitcnt vmcnt(23)
    global_load_lds_dwordx4 v3, s[8:9] offset:0
    v_add_u32 v3, s46, v3
    s_waitcnt vmcnt(23)
    global_load_lds_dwordx4 v3, s[8:9] offset:1024
    v_add_u32 v3, s46, v3
    s_waitcnt vmcnt(23)
    global_load_lds_dwordx4 v3, s[8:9] offset:2048
    v_add_u32 v3, s46, v3
    s_waitcnt vmcnt(23)
    global_load_lds_dwordx4 v3, s[8:9] offset:3072
    s_addk_i32 m0, 4096
    v_xor_b32 v3, 0x60000, v4
    s_waitcnt vmcnt(23)
    global_load_lds_dwordx4 v3, s[8:9] offset:0
    v_add_u32 v3, s46, v3
    s_waitcnt vmcnt(23)
    global_load_lds_dwordx4 v3, s[8:9] offset:1024
    v_add_u32 v3, s46, v3
    s_waitcnt vmcnt(23)
    global_load_lds_dwordx4 v3, s[8:9] offset:2048
    v_add_u32 v3, s46, v3
    s_waitcnt vmcnt(23)
    global_load_lds_dwordx4 v3, s[8:9] offset:3072
    s_addk_i32 m0, 4096
    s_waitcnt vmcnt(23)
    global_load_lds_dwordx4 v10, s[8:9] offset:0
    s_addk_i32 m0, 4096
    s_waitcnt vmcnt(23)
    global_load_lds_dwordx4 v11, s[8:9] offset:0
    s_addk_i32 m0, 4096
    s_waitcnt vmcnt(23)
    global_load_lds_dwordx4 v12, s[8:9] offset:0
    s_addk_i32 m0, 4096
    s_waitcnt vmcnt(23)
    global_load_lds_dwordx4 v13, s[8:9] offset:0
    s_addk_i32 m0, -11392
    s_waitcnt vmcnt(23)
    global_load_lds_dwordx4 v10, s[8:9] offset:128
    s_addk_i32 m0, 4096
    s_waitcnt vmcnt(23)
    global_load_lds_dwordx4 v11, s[8:9] offset:128
    s_addk_i32 m0, 4096
    s_waitcnt vmcnt(23)
    global_load_lds_dwordx4 v12, s[8:9] offset:128
    s_addk_i32 m0, 4096
    s_waitcnt vmcnt(23)
    global_load_lds_dwordx4 v13, s[8:9] offset:128
    s_addk_i32 m0, -11392
    s_barrier
    s_waitcnt vmcnt(23)
    s_mov_b32 s40, m0
    s_mov_b32 m0, 115712
    s_nop 0
    global_load_lds_dwordx4 v15, s[28:29] offset:0 sc1
    s_waitcnt vmcnt(23)
    s_mov_b32 exec_hi, 0xffff
    global_load_lds_dwordx4 v15, s[28:29] offset:1024 sc1
    s_mov_b32 exec_hi, -1
    s_mov_b32 m0, s40
    s_waitcnt vmcnt(23)
    global_load_lds_dwordx4 v10, s[8:9] offset:256
    s_addk_i32 m0, 4096
    s_waitcnt vmcnt(23)
    global_load_lds_dwordx4 v11, s[8:9] offset:256
    s_addk_i32 m0, 4096
    s_waitcnt vmcnt(23)
    global_load_lds_dwordx4 v12, s[8:9] offset:256
    s_addk_i32 m0, 4096
    s_waitcnt vmcnt(23)
    global_load_lds_dwordx4 v13, s[8:9] offset:256
    s_addk_i32 m0, -11392
    s_waitcnt vmcnt(23)
    global_load_lds_dwordx4 v10, s[8:9] offset:384
    s_addk_i32 m0, 4096
    s_barrier
    global_load_lds_dwordx4 v11, s[8:9] offset:384
    s_addk_i32 m0, 4096
    s_nop 0
    global_load_lds_dwordx4 v12, s[8:9] offset:384
    s_addk_i32 m0, 4096
    s_nop 0
    global_load_lds_dwordx4 v13, s[8:9] offset:384
    s_movk_i32 m0, 25600
    s_nop 0
    global_load_lds_dwordx4 v8, s[20:21] offset:0
    v_add_u32 v8, 0x6c00, v8
    s_barrier
    s_waitcnt vmcnt(23)
    global_load_lds_dwordx4 v8, s[20:21] offset:1024
    v_add_u32 v8, 0xffff9a00, v8
    s_waitcnt vmcnt(23)
    global_load_lds_dwordx4 v8, s[20:21] offset:2048
    v_add_u32 v8, 0x6c00, v8
    s_waitcnt vmcnt(23)
    global_load_lds_dwordx4 v8, s[20:21] offset:3072
    s_addk_i32 m0, 4096
    v_add_u32 v8, 0xffffaa00, v8
    s_waitcnt vmcnt(23)
    global_load_lds_dwordx4 v8, s[20:21] offset:0
    v_add_u32 v8, 0x6c00, v8
    s_waitcnt vmcnt(23)
    global_load_lds_dwordx4 v8, s[20:21] offset:1024
    v_add_u32 v8, 0xffff9a00, v8
    s_barrier
    s_waitcnt vmcnt(23)
    global_load_lds_dwordx4 v8, s[20:21] offset:2048
    v_add_u32 v8, 0x6c00, v8
    s_waitcnt vmcnt(23)
    global_load_lds_dwordx4 v8, s[20:21] offset:3072
    s_addk_i32 m0, 4096
    s_waitcnt vmcnt(23)
    global_load_lds_dwordx4 v9, s[12:13] offset:0
    v_add_u32 v9, 0x1800, v9
    s_waitcnt vmcnt(23)
    global_load_lds_dwordx4 v9, s[12:13] offset:1024
    v_add_u32 v9, 0xc000, v9
    s_waitcnt vmcnt(14)
    s_barrier
    s_waitcnt vmcnt(10)
    s_barrier
    s_barrier
    global_load_lds_dwordx4 v9, s[12:13] offset:2048
    v_add_u32 v9, 0x1800, v9
    global_load_lds_dwordx4 v9, s[12:13] offset:3072
    s_addk_i32 m0, 4096
    v_add_u32 v9, 0xd000, v9
    global_load_lds_dwordx4 v9, s[12:13] offset:0
    v_add_u32 v9, 0x1800, v9
    global_load_lds_dwordx4 v9, s[12:13] offset:1024
    v_add_u32 v9, 0xc000, v9
    global_load_lds_dwordx4 v9, s[12:13] offset:2048
    v_add_u32 v9, 0x1800, v9
    global_load_lds_dwordx4 v9, s[12:13] offset:3072
    s_addk_i32 m0, 4096
    v_add_u32 v9, 0xfffd8800, v9
    global_load_lds_dwordx4 v9, s[12:13] offset:0
    v_add_u32 v9, 0x1800, v9
    global_load_lds_dwordx4 v9, s[12:13] offset:1024
    v_add_u32 v9, 0xc000, v9
    global_load_lds_dwordx4 v9, s[12:13] offset:2048
    v_add_u32 v9, 0x1800, v9
    global_load_lds_dwordx4 v9, s[12:13] offset:3072
    s_addk_i32 m0, 4096
    v_add_u32 v9, 0xd000, v9
    global_load_lds_dwordx4 v9, s[12:13] offset:0
    v_add_u32 v9, 0x1800, v9
    global_load_lds_dwordx4 v9, s[12:13] offset:1024
    v_add_u32 v9, 0xc000, v9
    global_load_lds_dwordx4 v9, s[12:13] offset:2048
    v_add_u32 v9, 0x1800, v9
    global_load_lds_dwordx4 v9, s[12:13] offset:3072
    s_waitcnt vmcnt(16)
    s_barrier
    s_waitcnt vmcnt(4)
    s_barrier
    s_waitcnt vmcnt(0)
    s_barrier
    s_endpgm
.p2align 12
L_loadN:
    s_waitcnt vmcnt(21)
    global_load_lds_dwordx4 v3, s[6:7] offset:0
    v_add_u32 v3, s46, v3
    s_waitcnt vmcnt(21)
    global_load_lds_dwordx4 v3, s[6:7] offset:1024
    v_add_u32 v3, s46, v3
    s_waitcnt vmcnt(21)
    global_load_lds_dwordx4 v3, s[6:7] offset:2048
    v_add_u32 v3, s46, v3
    s_waitcnt vmcnt(21)
    global_load_lds_dwordx4 v3, s[6:7] offset:3072
    s_addk_i32 m0, 4096
    v_xor_b32 v3, 0x60000, v4
    s_waitcnt vmcnt(21)
    global_load_lds_dwordx4 v3, s[6:7] offset:0
    v_add_u32 v3, s46, v3
    s_waitcnt vmcnt(21)
    global_load_lds_dwordx4 v3, s[6:7] offset:1024
    v_add_u32 v3, s46, v3
    s_waitcnt vmcnt(21)
    global_load_lds_dwordx4 v3, s[6:7] offset:2048
    v_add_u32 v3, s46, v3
    s_waitcnt vmcnt(21)
    global_load_lds_dwordx4 v3, s[6:7] offset:3072
    s_addk_i32 m0, 4096
    v_xor_b32 v3, 0x80000, v4
    s_waitcnt vmcnt(21)
    global_load_lds_dwordx4 v3, s[6:7] offset:0
    v_add_u32 v3, s46, v3
    s_waitcnt vmcnt(21)
    global_load_lds_dwordx4 v3, s[6:7] offset:1024
    v_add_u32 v3, s46, v3
    s_waitcnt vmcnt(21)
    global_load_lds_dwordx4 v3, s[6:7] offset:2048
    v_add_u32 v3, s46, v3
    s_waitcnt vmcnt(21)
    global_load_lds_dwordx4 v3, s[6:7] offset:3072
    s_addk_i32 m0, 4096
    v_xor_b32 v3, 0xa0000, v4
    s_waitcnt vmcnt(21)
    global_load_lds_dwordx4 v3, s[6:7] offset:0
    v_add_u32 v3, s46, v3
    s_waitcnt vmcnt(21)
    global_load_lds_dwordx4 v3, s[6:7] offset:1024
    v_add_u32 v3, s46, v3
    s_barrier
    s_barrier
    s_waitcnt vmcnt(21)
    global_load_lds_dwordx4 v3, s[6:7] offset:2048
    v_add_u32 v3, s46, v3
    s_waitcnt vmcnt(21)
    global_load_lds_dwordx4 v3, s[6:7] offset:3072
    s_addk_i32 m0, 4096
    v_xor_b32 v3, 0xc0000, v4
    s_waitcnt vmcnt(21)
    global_load_lds_dwordx4 v3, s[6:7] offset:0
    v_add_u32 v3, s46, v3
    s_waitcnt vmcnt(21)
    global_load_lds_dwordx4 v3, s[6:7] offset:1024
    v_add_u32 v3, s46, v3
    s_waitcnt vmcnt(21)
    global_load_lds_dwordx4 v3, s[6:7] offset:2048
    v_add_u32 v3, s46, v3
    s_waitcnt vmcnt(21)
    global_load_lds_dwordx4 v3, s[6:7] offset:3072
    s_addk_i32 m0, 4096
    v_xor_b32 v3, 0xe0000, v4
    s_waitcnt vmcnt(21)
    global_load_lds_dwordx4 v3, s[6:7] offset:0
    v_add_u32 v3, s46, v3
    s_waitcnt vmcnt(21)
    global_load_lds_dwordx4 v3, s[6:7] offset:1024
    v_add_u32 v3, s46, v3
    s_waitcnt vmcnt(21)
    global_load_lds_dwordx4 v3, s[6:7] offset:2048
    v_add_u32 v3, s46, v3
    s_waitcnt vmcnt(21)
    global_load_lds_dwordx4 v3, s[6:7] offset:3072
    s_addk_i32 m0, 4096
    v_mov_b32 v3, v4
    s_waitcnt vmcnt(21)
    global_load_lds_dwordx4 v3, s[8:9] offset:0
    v_add_u32 v3, s46, v3
    s_waitcnt vmcnt(21)
    global_load_lds_dwordx4 v3, s[8:9] offset:1024
    v_add_u32 v3, s46, v3
    s_waitcnt vmcnt(21)
    global_load_lds_dwordx4 v3, s[8:9] offset:2048
    v_add_u32 v3, s46, v3
    s_waitcnt vmcnt(21)
    global_load_lds_dwordx4 v3, s[8:9] offset:3072
    s_addk_i32 m0, 4096
    v_xor_b32 v3, 0x20000, v4
    s_waitcnt vmcnt(21)
    global_load_lds_dwordx4 v3, s[8:9] offset:0
    v_add_u32 v3, s46, v3
    s_waitcnt vmcnt(21)
    global_load_lds_dwordx4 v3, s[8:9] offset:1024
    v_add_u32 v3, s46, v3
    s_waitcnt vmcnt(21)
    global_load_lds_dwordx4 v3, s[8:9] offset:2048
    v_add_u32 v3, s46, v3
    s_waitcnt vmcnt(21)
    global_load_lds_dwordx4 v3, s[8:9] offset:3072
    s_addk_i32 m0, 4096
    v_xor_b32 v3, 0x40000, v4
    s_waitcnt vmcnt(21)
    global_load_lds_dwordx4 v3, s[8:9] offset:0
    v_add_u32 v3, s46, v3
    s_waitcnt vmcnt(21)
    global_load_lds_dwordx4 v3, s[8:9] offset:1024
    v_add_u32 v3, s46, v3
    s_waitcnt vmcnt(21)
    global_load_lds_dwordx4 v3, s[8:9] offset:2048
    v_add_u32 v3, s46, v3
    s_waitcnt vmcnt(21)
    global_load_lds_dwordx4 v3, s[8:9] offset:3072
    s_addk_i32 m0, 4096
    v_xor_b32 v3, 0x60000, v4
    s_waitcnt vmcnt(21)
    global_load_lds_dwordx4 v3, s[8:9] offset:0
    v_add_u32 v3, s46, v3
    s_waitcnt vmcnt(21)
    global_load_lds_dwordx4 v3, s[8:9] offset:1024
    v_add_u32 v3, s46, v3
    s_waitcnt vmcnt(21)
    global_load_lds_dwordx4 v3, s[8:9] offset:2048
    v_add_u32 v3, s46, v3
    s_barrier
    s_waitcnt vmcnt(21)
    global_load_lds_dwordx4 v3, s[8:9] offset:3072
    s_addk_i32 m0, 4096
    s_waitcnt vmcnt(21)
    global_load_lds_dwordx4 v10, s[8:9] offset:0
    s_addk_i32 m0, 4096
    s_waitcnt vmcnt(21)
    global_load_lds_dwordx4 v11, s[8:9] offset:0
    s_addk_i32 m0, 4096
    s_waitcnt vmcnt(21)
    global_load_lds_dwordx4 v12, s[8:9] offset:0
    s_addk_i32 m0, 4096
    s_waitcnt vmcnt(21)
    global_load_lds_dwordx4 v13, s[8:9] offset:0
    s_addk_i32 m0, -11392
    s_waitcnt vmcnt(21)
    global_load_lds_dwordx4 v10, s[8:9] offset:128
    s_addk_i32 m0, 4096
    s_waitcnt vmcnt(21)
    global_load_lds_dwordx4 v11, s[8:9] offset:128
    s_addk_i32 m0, 4096
    s_barrier
    s_waitcnt vmcnt(21)
    global_load_lds_dwordx4 v12, s[8:9] offset:128
    s_addk_i32 m0, 4096
    s_waitcnt vmcnt(21)
    global_load_lds_dwordx4 v13, s[8:9] offset:128
    s_addk_i32 m0, -11392
    s_waitcnt vmcnt(21)
    global_load_lds_dwordx4 v10, s[8:9] offset:256
    s_addk_i32 m0, 4096
    s_waitcnt vmcnt(21)
    global_load_lds_dwordx4 v11, s[8:9] offset:256
    s_addk_i32 m0, 4096
    s_waitcnt vmcnt(21)
    global_load_lds_dwordx4 v12, s[8:9] offset:256
    s_addk_i32 m0, 4096
    s_waitcnt vmcnt(21)
    global_load_lds_dwordx4 v13, s[8:9] offset:256
    s_addk_i32 m0, -11392
    s_waitcnt vmcnt(21)
    global_load_lds_dwordx4 v10, s[8:9] offset:384
    s_addk_i32 m0, 4096
    s_waitcnt vmcnt(21)
    global_load_lds_dwordx4 v11, s[8:9] offset:384
    s_addk_i32 m0, 4096
    s_waitcnt vmcnt(21)
    global_load_lds_dwordx4 v12, s[8:9] offset:384
    s_addk_i32 m0, 4096
    s_waitcnt vmcnt(21)
    global_load_lds_dwordx4 v13, s[8:9] offset:384
L_cload:
    s_lshr_b32 s35, s43, 2
    s_lshl_b32 s35, s35, 14
    s_and_b32 s47, s43, 3
    s_lshl_b32 s47, s47, 11
    s_add_u32 s47, s47, s35
    s_add_u32 s47, s47, 262144
    v_lshl_add_u32 v29, v0, 4, s47
    s_lshl_b32 s34, s43, 4
    v_and_b32 v16, 3, v0
    v_lshl_add_u32 v19, v16, 2, v2
    v_add_lshl_u32 v19, v19, s34, 1
    s_lshl_b32 s48, s43, 8
    s_add_u32 s48, s48, 491520
    s_load_dword s50, s[28:29], s48 glc
    s_load_dword s51, s[28:29], s48 offset:0x2100 glc
    s_waitcnt vmcnt(17)
    s_barrier
    s_barrier
    s_waitcnt vmcnt(16)
    s_barrier
    s_waitcnt vmcnt(4)
    s_barrier
    s_waitcnt vmcnt(0)
    s_barrier
    s_barrier
    global_load_ushort v30, v19, s[4:5]
    global_load_ushort v31, v19, s[22:23]
    s_mov_b32 s60, 0x0c0c0400
    s_mov_b32 s61, 0x0504000c
    s_mov_b32 s45, 0
    s_waitcnt lgkmcnt(0)
    s_mul_i32 s38, s38, 1664525
    s_add_u32 s38, s38, 1013904223
    s_mov_b32 s49, 0
    s_not_b32 s53, s51
    s_load_dword s52, s[28:29], s48 glc
    s_load_dword s53, s[28:29], s48 offset:0x2100 glc
    s_waitcnt lgkmcnt(1)
    s_cmp_eq_u32 s53, s51
    s_addc_u32 s49, s49, 0
    s_waitcnt lgkmcnt(0)
    s_not_b32 s53, s51
    s_load_dword s52, s[28:29], s48 glc
    s_load_dword s53, s[28:29], s48 offset:0x2100 glc
    s_waitcnt lgkmcnt(1)
    s_cmp_eq_u32 s53, s51
    s_addc_u32 s49, s49, 0
    s_waitcnt lgkmcnt(0)
    s_not_b32 s53, s51
    s_load_dword s52, s[28:29], s48 glc
    s_load_dword s53, s[28:29], s48 offset:0x2100 glc
    s_waitcnt lgkmcnt(1)
    s_cmp_eq_u32 s53, s51
    s_addc_u32 s49, s49, 0
    s_waitcnt lgkmcnt(0)
    s_cmp_gt_u32 s49, 1
    s_cselect_b32 s49, 0x2000, 0
    v_add_u32 v29, s49, v29
    s_waitcnt vmcnt(0)
    v_lshlrev_b32 v30, 16, v30
    v_lshlrev_b32 v31, 16, v31
    v_add_f32 v30, v30, v31
    s_barrier
    global_load_dwordx4 v[40:43], v29, s[28:29] sc1
    global_load_dwordx4 v[44:47], v29, s[28:29] offset:1024 sc1
    global_load_dwordx4 v[48:51], v29, s[28:29] sc1
    global_load_dwordx4 v[52:55], v29, s[28:29] offset:1024 sc1
L_ppoll:
    global_load_dwordx4 v[56:59], v29, s[28:29] sc1
    global_load_dwordx4 v[60:63], v29, s[28:29] offset:1024 sc1
    s_add_u32 s45, s45, 1
    s_cmp_ge_u32 s45, 32768
    s_cbranch_scc1 L_pok
    s_waitcnt vmcnt(4)
    v_cmp_ne_u32 vcc, s38, v43
    v_cmp_ne_u32 s[54:55], s38, v47
    v_perm_b32 v36, v40, v41, s60
    v_perm_b32 v37, v44, v45, s60
    v_perm_b32 v36, v36, v42, s61
    v_perm_b32 v37, v37, v46, s61
    v_pk_add_f32 v[32:33], v[40:41], v[44:45]
    v_add_f32 v34, v42, v46
    v_add_f32 v35, v36, v37
    s_or_b64 vcc, vcc, s[54:55]
    s_cbranch_scc0 L_pok
    global_load_dwordx4 v[40:43], v29, s[28:29] sc1
    global_load_dwordx4 v[44:47], v29, s[28:29] offset:1024 sc1
    s_waitcnt vmcnt(4)
    v_cmp_ne_u32 vcc, s38, v51
    v_cmp_ne_u32 s[54:55], s38, v55
    v_perm_b32 v36, v48, v49, s60
    v_perm_b32 v37, v52, v53, s60
    v_perm_b32 v36, v36, v50, s61
    v_perm_b32 v37, v37, v54, s61
    v_pk_add_f32 v[32:33], v[48:49], v[52:53]
    v_add_f32 v34, v50, v54
    v_add_f32 v35, v36, v37
    s_or_b64 vcc, vcc, s[54:55]
    s_cbranch_scc0 L_pok
    global_load_dwordx4 v[48:51], v29, s[28:29] sc1
    global_load_dwordx4 v[52:55], v29, s[28:29] offset:1024 sc1
    s_waitcnt vmcnt(4)
    v_cmp_ne_u32 vcc, s38, v59
    v_cmp_ne_u32 s[54:55], s38, v63
    v_perm_b32 v36, v56, v57, s60
    v_perm_b32 v37, v60, v61, s60
    v_perm_b32 v36, v36, v58, s61
    v_perm_b32 v37, v37, v62, s61
    v_pk_add_f32 v[32:33], v[56:57], v[60:61]
    v_add_f32 v34, v58, v62
    v_add_f32 v35, v36, v37
    s_or_b64 vcc, vcc, s[54:55]
    s_cbranch_scc1 L_ppoll
L_pok:
    v_permlane32_swap_b32 v32, v34
    v_permlane32_swap_b32 v33, v35
    v_pk_add_f32 v[32:33], v[32:33], v[34:35]
    s_nop 1
    v_permlane16_swap_b32 v32, v33
    v_add_f32 v32, v32, v33
    s_nop 1
    v_add_f32_dpp v32, v32, v32 row_ror:4 row_mask:0xf bank_mask:0xf
    s_nop 1
    v_add_f32_dpp v32, v32, v32 row_ror:8 row_mask:0xf bank_mask:0xf
    s_mov_b32 exec_lo, 0x000f000f
    s_mov_b32 exec_hi, 0x000f000f
    v_add_f32 v32, v32, v30
    v_cvt_pk_bf16_f32 v32, v32, v32
    global_store_short v19, v32, s[24:25]
    s_cmp_eq_u32 s43, 0
    s_cbranch_scc0 L_end
    s_mov_b64 exec, 1
    v_mov_b32 v2, 0
    v_mov_b32 v38, s38
    global_store_dword v2, v38, s[28:29]
    s_endpgm
L_comp:
    s_sub_u32 s3, s3, 1
    v_and_b32 v1, 15, v0
    v_lshrrev_b32 v8, 3, v1
    v_and_b32 v16, 3, v0
    s_lshl_b32 s34, s30, 13
    s_xor_b32 s35, s33, 4
    s_lshl3_add_u32 s35, s32, s35
    s_lshl_b32 s35, s35, 8
    s_add_u32 s35, s34, s35
    s_add_u32 s56, s35, 65536
    s_lshl_b32 s36, s3, 6
    s_add_u32 s35, s56, s36
    v_lshl_add_u32 v30, v2, 4, s35
    s_lshl3_add_u32 s35, s43, s33
    s_lshl_b32 s35, s35, 8
    s_add_u32 s57, s35, 131072
    s_add_u32 s35, s57, s36
    v_lshl_add_u32 v31, v2, 4, s35
    global_load_dword v148, v30, s[28:29]
    global_load_dword v148, v31, s[28:29]
    v_bfe_u32 v14, v0, 2, 3
    v_lshlrev_b32 v14, 7, v14
    v_and_b32 v15, 3, v7
    v_lshl_add_u32 v14, v15, 5, v14
    v_lshl_add_u32 v14, v16, 3, v14
    v_lshrrev_b32 v15, 5, v0
    s_lshl_b32 s36, s3, 5
    v_xor_b32 v24, s36, v14
    v_lshl_add_u32 v20, v15, 12, v24
    v_add_u32 v20, 82944, v20
    v_lshl_add_u32 v24, v15, 10, v24
    s_mul_i32 s35, s32, 224
    v_lshl_add_u32 v28, v2, 3, s35
    s_lshl_b32 s35, s33, 7
    v_lshl_add_u32 v29, v2, 3, s35
    s_mov_b32 s50, 0x07060503
    s_mov_b32 s51, 0x07060502
    s_mov_b32 s52, 0x07060501
    s_getreg_b32 s39, hwreg(HW_REG_XCC_ID, 0, 4)
    v_mov_b32 v46, 0
    v_mov_b32 v47, 0
    v_mov_b32 v78, 0
    v_mov_b32 v79, 0
    s_mov_b32 s37, 0
    v_mov_b32 v26, 0
    s_cmp_eq_u32 s3, 0
    s_cbranch_scc0 L_noln
    s_waitcnt vmcnt(2)
    v_lshlrev_b32 v32, 16, v140
    v_and_b32 v33, 0xffff0000, v140
    v_lshlrev_b32 v34, 16, v141
    v_and_b32 v35, 0xffff0000, v141
    v_lshlrev_b32 v36, 16, v142
    v_and_b32 v37, 0xffff0000, v142
    v_lshlrev_b32 v38, 16, v143
    v_and_b32 v39, 0xffff0000, v143
    v_pk_add_f32 v[40:41], v[32:33], v[34:35]
    v_pk_add_f32 v[42:43], v[36:37], v[38:39]
    v_pk_add_f32 v[40:41], v[40:41], v[42:43]
    v_add_f32 v40, v40, v41
    s_nop 1
    v_add_f32_dpp v40, v40, v40 row_ror:1 row_mask:0xf bank_mask:0xf
    s_nop 1
    v_add_f32_dpp v40, v40, v40 row_ror:2 row_mask:0xf bank_mask:0xf
    s_nop 1
    v_add_f32_dpp v40, v40, v40 row_ror:4 row_mask:0xf bank_mask:0xf
    s_nop 1
    v_add_f32_dpp v40, v40, v40 row_ror:8 row_mask:0xf bank_mask:0xf
    v_mov_b32 v41, v40
    s_nop 1
    v_permlane16_swap_b32 v41, v40
    v_add_f32 v40, v40, v41
    v_mov_b32 v41, v40
    s_nop 1
    v_permlane32_swap_b32 v41, v40
    v_add_f32 v40, v40, v41
    v_mul_f32 v40, 0x3b124925, v40
    v_mov_b32 v42, 0
    v_mov_b32 v43, 0
    s_bfm_b64 exec, 56, 0
    v_pk_add_f32 v[44:45], v[32:33], v[40:41] op_sel_hi:[1,0] neg_lo:[0,1] neg_hi:[0,1]
    v_pk_fma_f32 v[42:43], v[44:45], v[44:45], v[42:43]
    v_pk_add_f32 v[44:45], v[34:35], v[40:41] op_sel_hi:[1,0] neg_lo:[0,1] neg_hi:[0,1]
    v_pk_fma_f32 v[42:43], v[44:45], v[44:45], v[42:43]
    v_pk_add_f32 v[44:45], v[36:37], v[40:41] op_sel_hi:[1,0] neg_lo:[0,1] neg_hi:[0,1]
    v_pk_fma_f32 v[42:43], v[44:45], v[44:45], v[42:43]
    v_pk_add_f32 v[44:45], v[38:39], v[40:41] op_sel_hi:[1,0] neg_lo:[0,1] neg_hi:[0,1]
    v_pk_fma_f32 v[42:43], v[44:45], v[44:45], v[42:43]
    s_mov_b64 exec, -1
    v_add_f32 v42, v42, v43
    s_nop 1
    v_add_f32_dpp v42, v42, v42 row_ror:1 row_mask:0xf bank_mask:0xf
    s_nop 1
    v_add_f32_dpp v42, v42, v42 row_ror:2 row_mask:0xf bank_mask:0xf
    s_nop 1
    v_add_f32_dpp v42, v42, v42 row_ror:4 row_mask:0xf bank_mask:0xf
    s_nop 1
    v_add_f32_dpp v42, v42, v42 row_ror:8 row_mask:0xf bank_mask:0xf
    v_mov_b32 v41, v42
    s_nop 1
    v_permlane16_swap_b32 v41, v42
    v_add_f32 v42, v42, v41
    v_mov_b32 v41, v42
    s_nop 1
    v_permlane32_swap_b32 v41, v42
    v_add_f32 v42, v42, v41
    v_mul_f32 v42, 0x3b124925, v42
    v_cvt_pk_bf16_f32 v40, v40, v42
    v_and_b32 v42, 0xffff0000, v40
    v_lshlrev_b32 v40, 16, v40
    v_add_f32 v42, 0x3727c5ac, v42
    v_cvt_pk_bf16_f32 v42, v42, v42
    v_lshlrev_b32 v42, 16, v42
    v_sqrt_f32 v42, v42
    v_pk_add_f32 v[32:33], v[32:33], v[40:41] op_sel_hi:[1,0] neg_lo:[0,1] neg_hi:[0,1]
    v_pk_add_f32 v[34:35], v[34:35], v[40:41] op_sel_hi:[1,0] neg_lo:[0,1] neg_hi:[0,1]
    v_pk_add_f32 v[36:37], v[36:37], v[40:41] op_sel_hi:[1,0] neg_lo:[0,1] neg_hi:[0,1]
    v_pk_add_f32 v[38:39], v[38:39], v[40:41] op_sel_hi:[1,0] neg_lo:[0,1] neg_hi:[0,1]
    v_cvt_pk_bf16_f32 v42, v42, v42
    v_lshlrev_b32 v42, 16, v42
    v_rcp_f32 v42, v42
    v_cvt_pk_bf16_f32 v56, v32, v33
    v_cvt_pk_bf16_f32 v57, v34, v35
    v_cvt_pk_bf16_f32 v58, v36, v37
    v_cvt_pk_bf16_f32 v59, v38, v39
    v_lshlrev_b32 v32, 16, v56
    v_and_b32 v33, 0xffff0000, v56
    v_lshlrev_b32 v34, 16, v57
    v_and_b32 v35, 0xffff0000, v57
    v_lshlrev_b32 v36, 16, v58
    v_and_b32 v37, 0xffff0000, v58
    v_lshlrev_b32 v38, 16, v59
    v_and_b32 v39, 0xffff0000, v59
    v_pk_mul_f32 v[32:33], v[32:33], v[42:43] op_sel_hi:[1,0]
    v_pk_mul_f32 v[34:35], v[34:35], v[42:43] op_sel_hi:[1,0]
    v_pk_mul_f32 v[36:37], v[36:37], v[42:43] op_sel_hi:[1,0]
    v_pk_mul_f32 v[38:39], v[38:39], v[42:43] op_sel_hi:[1,0]
    v_cvt_pk_bf16_f32 v56, v32, v33
    v_cvt_pk_bf16_f32 v57, v34, v35
    v_cvt_pk_bf16_f32 v58, v36, v37
    v_cvt_pk_bf16_f32 v59, v38, v39
    ds_write_b128 v3, v[56:59] offset:22528
L_noln:
    s_waitcnt lgkmcnt(0)
    s_mul_i32 s38, s38, 1664525
    s_add_u32 s38, s38, 1013904223
    s_add_u32 s39, s39, s38
    v_mov_b32 v63, s39
    s_barrier
    ds_read_b64 v[32:33], v28 offset:22528
    ds_read_b64_tr_b16 v[64:65], v24 offset:8192
    ds_read_b64 v[34:35], v28 offset:22560
    ds_read_b64_tr_b16 v[66:67], v24 offset:10240
    ds_read_b64 v[36:37], v28 offset:22592
    ds_read_b64_tr_b16 v[68:69], v24 offset:12288
    ds_read_b64 v[38:39], v28 offset:22624
    ds_read_b64_tr_b16 v[70:71], v24 offset:14336
    ds_read_b64 v[40:41], v28 offset:22656
    ds_read_b64_tr_b16 v[72:73], v24 offset:16384
    ds_read_b64 v[42:43], v28 offset:22688
    ds_read_b64_tr_b16 v[74:75], v24 offset:18432
    ds_read_b64 v[44:45], v28 offset:22720
    ds_read_b64_tr_b16 v[76:77], v24 offset:20480
    s_waitcnt lgkmcnt(10)
    v_mfma_f32_16x16x32_bf16 v[56:59], v[64:67], v[32:35], 0
    s_waitcnt lgkmcnt(6)
    v_mfma_f32_16x16x32_bf16 v[56:59], v[68:71], v[36:39], v[56:59]
    s_waitcnt lgkmcnt(2)
    v_mfma_f32_16x16x32_bf16 v[56:59], v[72:75], v[40:43], v[56:59]
    s_waitcnt lgkmcnt(0)
    v_mfma_f32_16x16x32_bf16 v[56:59], v[76:79], v[44:47], v[56:59]
    ds_read_b64 v[48:49], v29 offset:22528
    ds_read_b64 v[50:51], v29 offset:22560
    ds_read_b64 v[52:53], v29 offset:22592
    ds_read_b64 v[54:55], v29 offset:22624
    s_mov_b32 exec_lo, 0x00010001
    s_mov_b32 exec_hi, 0x00010001
    s_nop 1
    v_perm_b32 v60, v56, v59, s50
    v_perm_b32 v61, v57, v59, s51
    v_perm_b32 v62, v58, v59, s52
    global_store_dwordx4 v30, v[60:63], s[28:29]
    s_barrier
    s_mov_b64 exec, -1
    s_cmp_eq_u32 s63, 0
    s_cbranch_scc1 L_noh
    s_barrier
    ds_read_b64_tr_b16 v[64:65], v24 offset:0
    ds_read_b64_tr_b16 v[66:67], v24 offset:2048
    ds_read_b64_tr_b16 v[68:69], v24 offset:4096
    ds_read_b64_tr_b16 v[70:71], v24 offset:6144
    v_mov_b32 v63, s38
    s_waitcnt lgkmcnt(2)
    v_mfma_f32_16x16x32_bf16 v[56:59], v[64:67], v[48:51], 0
    s_waitcnt lgkmcnt(0)
    v_mfma_f32_16x16x32_bf16 v[56:59], v[68:71], v[52:55], v[56:59]
    s_lshl_b32 s35, s43, 7
    v_lshl_add_u32 v6, v16, 3, s35
    v_lshl_add_u32 v6, v2, 5, v6
    global_load_dwordx2 v[80:81], v6, s[18:19]
    s_mov_b32 exec_lo, 0x00010001
    s_mov_b32 exec_hi, 0x00010001
    s_nop 1
    v_perm_b32 v60, v56, v59, s50
    v_perm_b32 v61, v57, v59, s51
    v_perm_b32 v62, v58, v59, s52
    global_store_dwordx4 v31, v[60:63], s[28:29]
    s_mov_b64 exec, -1
    s_branch L_hdone
L_noh:
    s_cmp_lt_u32 s31, 28
    s_cbranch_scc1 L_hdone
    s_lshl_b32 s36, s30, 11
    s_and_b32 s35, s32, 1
    s_lshl_b32 s35, s35, 10
    s_add_u32 s36, s36, s35
    s_lshr_b32 s35, s3, 1
    s_lshl_b32 s35, s35, 9
    s_add_u32 s36, s36, s35
    s_lshr_b32 s35, s32, 1
    s_lshl_b32 s35, s35, 8
    s_add_u32 s36, s36, s35
    s_add_u32 s36, s36, 196608
    v_lshl_add_u32 v26, v7, 5, s36
    v_lshl_add_u32 v26, v16, 3, v26
    s_lshl2_add_u32 s36, s44, s3
    s_lshl_b32 s35, s36, 12
    s_add_u32 s35, s35, 524288
    v_lshl_add_u32 v30, v0, 4, s35
    s_lshl_b32 s35, s36, 7
    s_add_u32 s35, s35, 229376
    v_lshl_add_u32 v28, v5, 4, s35
    global_load_dword v148, v26, s[28:29]
    global_load_dword v148, v28, s[28:29]
    s_lshr_b32 s35, s43, 2
    s_lshl_b32 s35, s35, 14
    s_and_b32 s40, s43, 3
    s_lshl_b32 s40, s40, 11
    s_add_u32 s35, s35, s40
    s_lshl_b32 s40, s3, 9
    s_add_u32 s35, s35, s40
    s_add_u32 s37, s35, 262144
    s_lshl_b32 s36, s43, 5
    s_lshr_b32 s33, s32, 1
    s_lshl_b32 s33, s33, 3
    s_load_dword s41, s[22:23], s36
    s_load_dword s41, s[24:25], s36
    s_load_dword s41, s[28:29], s37 offset:0
    s_load_dword s41, s[28:29], s37 offset:64
    s_load_dword s41, s[28:29], s37 offset:128
    s_load_dword s41, s[28:29], s37 offset:192
    s_load_dword s41, s[28:29], s37 offset:256
    s_load_dword s41, s[28:29], s37 offset:320
    s_load_dword s41, s[28:29], s37 offset:384
    s_load_dword s41, s[28:29], s37 offset:448
L_hdone:
    s_lshl_b32 s35, s3, 9
    s_add_u32 s34, s34, s35
    s_add_u32 s34, s34, 65536
    v_and_b32 v10, 31, v0
    v_lshl_add_u32 v18, v15, 11, s34
    v_lshl_add_u32 v18, v10, 4, v18
    v_add_u32 v19, 0x1000, v18
    s_lshl_b32 s34, s30, 16
    s_lshl_b32 s35, s3, 13
    s_add_u32 s35, s35, s34
    s_lshl_b32 s36, s31, 7
    s_add_u32 s35, s35, s36
    s_add_u32 s35, s35, 524288
    v_lshl_add_u32 v14, v8, 15, s35
    v_lshl_add_u32 v14, v15, 12, v14
    v_and_b32 v9, 1, v2
    v_lshl_add_u32 v14, v9, 6, v14
    v_lshl_add_u32 v14, v16, 4, v14
    s_barrier
    global_load_dwordx4 v[64:67], v18, s[28:29] sc1
    global_load_dwordx4 v[68:71], v19, s[28:29] sc1
    s_lshr_b32 s34, s3, 1
    s_mul_i32 s34, s34, 576
    s_and_b32 s35, s3, 1
    s_lshl_b32 s35, s35, 8
    s_add_u32 s34, s34, s35
    v_lshl_add_u32 v10, v10, 3, s34
    v_lshl_add_u32 v17, v15, 2, v10
    v_mul_u32_u24 v9, 576, v8
    v_lshl_add_u32 v9, v2, 4, v9
    v_mul_u32_u24 v10, 384, v8
    v_lshl_add_u32 v10, v2, 6, v10
    s_lshl_b32 s36, s3, 4
    v_add_u32 v11, s36, v10
    v_lshlrev_b32 v12, 2, v8
    v_mov_b32 v13, 0xff800000
    ds_write_b32 v12, v13 offset:25472
    s_lshl_b32 s36, s3, 2
    v_mov_b32 v25, s36
    s_lshl_b32 s36, s3, 13
    s_add_u32 s36, s36, 50176
    v_lshl_add_u32 v3, v8, 12, s36
    v_lshl_add_u32 v3, v5, 7, v3
    v_and_b32 v4, 6, v0
    v_xor_b32 v4, v4, v2
    v_lshl_add_u32 v3, v4, 4, v3
    v_xor_b32 v4, 64, v3
    s_lshl_b32 s34, s30, 11
    s_lshl_b32 s35, s3, 9
    s_add_u32 s34, s34, s35
    s_and_b32 s35, s31, 7
    s_lshl_b32 s35, s35, 5
    s_add_u32 s34, s34, s35
    s_and_b32 s35, s31, 24
    s_add_u32 s34, s34, s35
    s_add_u32 s34, s34, 196608
    v_lshl_add_u32 v13, v8, 8, s34
    s_mov_b32 s46, 0x01010101
    s_mov_b32 s47, s46
    s_mov_b32 s48, 0x0f0f0f0f
    s_mov_b32 s49, s48
    s_mov_b32 s53, 0x3db8aa3b
    s_mov_b32 s60, 0x0c0c0400
    s_mov_b32 s61, 0x0504000c
    s_mov_b32 s45, 0
    v_mov_b32 v152, 0x3f803f80
    v_mov_b32 v153, v152
    v_mov_b32 v154, v152
    v_mov_b32 v155, v152
    s_cmp_lt_u32 s31, 28
    s_cbranch_scc1 L_gsetup
    s_load_dword s41, s[28:29], s37 offset:8192
    s_load_dword s41, s[28:29], s37 offset:8256
    s_load_dword s41, s[28:29], s37 offset:8320
    s_load_dword s41, s[28:29], s37 offset:8384
    s_load_dword s41, s[28:29], s37 offset:8448
    s_load_dword s41, s[28:29], s37 offset:8512
    s_load_dword s41, s[28:29], s37 offset:8576
    s_load_dword s41, s[28:29], s37 offset:8640
    s_branch L_sdone
.p2align 12
L_gsetup:
    v_lshrrev_b32 v6, 2, v1
    v_lshlrev_b32 v6, 8, v6
    v_lshl_add_u32 v6, v2, 6, v6
    v_lshl_add_u32 v6, v16, 4, v6
    s_lshl_b32 s35, s43, 11
    s_add_u32 s35, s35, 131072
    v_add_u32 v26, s35, v6
    v_add_u32 v6, 115712, v6
    v_mov_b32 v76, 0
    v_mov_b32 v77, 0
    v_mov_b32 v78, 0
    v_mov_b32 v79, s38
    s_lshl_b32 s35, s44, 9
    s_add_u32 s35, s35, 229376
    v_bfe_u32 v28, v0, 2, 1
    v_lshl_add_u32 v28, v28, 8, s35
    v_lshl_add_u32 v28, v2, 6, v28
    v_lshl_add_u32 v28, v16, 4, v28
    s_lshl_b32 s35, s33, 14
    s_mov_b32 s36, s3
    s_lshl_b32 s36, s36, 11
    s_add_u32 s35, s35, s36
    s_lshl3_add_u32 s36, s32, s30
    s_lshl_b32 s36, s36, 6
    s_add_u32 s35, s35, s36
    s_add_u32 s35, s35, 262144
    v_lshl_add_u32 v29, v2, 4, s35
    v_add_u32 v30, 0x2000, v29
L_sdone:
    s_barrier
    ds_read_b128 v[32:35], v3 offset:0
    ds_read_b128 v[36:39], v4 offset:0
    ds_read_b128 v[40:43], v3 offset:1024
    ds_read_b128 v[44:47], v4 offset:1024
    ds_read_b128 v[48:51], v3 offset:2048
    ds_read_b128 v[52:55], v4 offset:2048
    ds_read_b128 v[56:59], v3 offset:3072
    ds_read_b128 v[60:63], v4 offset:3072
    s_waitcnt vmcnt(0)
L_qchk:
    v_cmp_ne_u32 vcc, s39, v67
    v_cmp_ne_u32 s[54:55], s39, v71
    v_perm_b32 v82, v64, v65, s60
    v_perm_b32 v83, v68, v69, s60
    v_perm_b32 v82, v82, v66, s61
    v_perm_b32 v83, v83, v70, s61
    s_or_b64 vcc, vcc, s[54:55]
    s_cbranch_scc1 L_qslow
    v_mov_b32 v67, 0
L_qok:
    v_add_f32 v64, v64, v68
    v_add_f32 v66, v66, v70
    v_add_f32 v65, v65, v69
    v_add_f32 v82, v82, v83
    v_permlane32_swap_b32 v64, v66
    ds_write_b32 v25, v67 offset:25504
    v_permlane32_swap_b32 v65, v82
    v_add_f32 v64, v64, v66
    v_add_f32 v65, v65, v82
    v_cvt_pk_bf16_f32 v64, v64, v65
    ds_write_b32 v17, v64 offset:23552
    v_mov_b32 v83, 0
    s_waitcnt lgkmcnt(0)
    s_barrier
    ds_read_b128 v[84:87], v9 offset:23552
    ds_read_b128 v[88:91], v9 offset:23616
    ds_read_b128 v[92:95], v9 offset:23680
    ds_read_b128 v[96:99], v9 offset:23744
    ds_read_b128 v[100:103], v9 offset:23808
    ds_read_b128 v[104:107], v9 offset:23872
    ds_read_b128 v[108:111], v9 offset:23936
    ds_read_b128 v[112:115], v9 offset:24000
    global_load_dword v148, v14, s[28:29]
    s_waitcnt lgkmcnt(7)
    v_mfma_f32_16x16x32_bf16 v[64:67], v[32:35], v[84:87], 0
    s_waitcnt lgkmcnt(6)
    v_mfma_f32_16x16x32_bf16 v[64:67], v[36:39], v[88:91], v[64:67]
    s_waitcnt lgkmcnt(5)
    v_mfma_f32_16x16x32_bf16 v[64:67], v[40:43], v[92:95], v[64:67]
    s_waitcnt lgkmcnt(4)
    v_mfma_f32_16x16x32_bf16 v[64:67], v[44:47], v[96:99], v[64:67]
    s_waitcnt lgkmcnt(3)
    v_mfma_f32_16x16x32_bf16 v[64:67], v[48:51], v[100:103], v[64:67]
    s_waitcnt lgkmcnt(2)
    v_mfma_f32_16x16x32_bf16 v[64:67], v[52:55], v[104:107], v[64:67]
    s_waitcnt lgkmcnt(1)
    v_mfma_f32_16x16x32_bf16 v[64:67], v[56:59], v[108:111], v[64:67]
    ds_read_b128 v[156:159], v83 offset:25504
    s_waitcnt lgkmcnt(1)
    v_mfma_f32_16x16x32_bf16 v[64:67], v[60:63], v[112:115], v[64:67]
    s_nop 7
    v_cvt_pk_bf16_f32 v68, v64, v65
    v_cvt_pk_bf16_f32 v69, v66, v67
    v_lshlrev_b32 v64, 16, v68
    v_and_b32 v65, 0xffff0000, v68
    v_lshlrev_b32 v66, 16, v69
    v_and_b32 v67, 0xffff0000, v69
    v_max_f32 v68, v64, v65
    v_max3_f32 v68, v66, v67, v68
    v_mul_f32 v68, s53, v68
    v_ceil_f32 v68, v68
    v_fma_f32 v64, v64, s53, -v68
    v_fma_f32 v65, v65, s53, -v68
    v_fma_f32 v66, v66, s53, -v68
    v_fma_f32 v67, v67, s53, -v68
    v_mul_f32 v70, 0x43000000, v68
    s_mov_b64 exec, s[46:47]
    ds_max_f32 v12, v70 offset:25472
    v_exp_f32 v64, v64
    v_exp_f32 v65, v65
    v_exp_f32 v66, v66
    v_exp_f32 v67, v67
    v_cvt_pk_bf16_f32 v68, v64, v65
    v_cvt_pk_bf16_f32 v69, v66, v67
    ds_write_b96 v11, v[68:70] offset:24704
    s_mov_b64 exec, -1
    s_lshl_b64 s[40:41], s[46:47], 1
    s_lshl_b64 s[42:43], s[46:47], 2
    s_lshl_b64 s[54:55], s[46:47], 3
    s_waitcnt lgkmcnt(2)
    v_or3_b32 v56, v156, v157, v158
    v_or_b32 v56, v56, v159
    v_mov_b32 v63, s38
    v_readfirstlane_b32 s62, v56
    v_mov_b32 v67, s38
    s_waitcnt lgkmcnt(0)
    s_barrier
    ds_read_b32 v68, v12 offset:25472
    ds_read_b128 v[32:35], v10 offset:24704
    ds_read_b128 v[36:39], v10 offset:24720
    ds_read_b128 v[40:43], v10 offset:24736
    ds_read_b128 v[44:47], v10 offset:24752
    s_waitcnt lgkmcnt(2)
    v_sub_f32 v34, v68, v34
    v_sub_f32 v38, v68, v38
    v_cvt_u32_f32 v34, v34
    v_cvt_u32_f32 v38, v38
    v_cvt_pk_u16_u32 v34, v34, v38
    v_pk_sub_u16 v48, v32, v34 op_sel_hi:[1,0] clamp
    v_pk_sub_u16 v49, v33, v34 op_sel_hi:[1,0] clamp
    v_pk_sub_u16 v50, v36, v34 op_sel:[0,1] clamp
    v_pk_sub_u16 v51, v37, v34 op_sel:[0,1] clamp
    s_waitcnt lgkmcnt(0)
    v_sub_f32 v42, v68, v42
    v_sub_f32 v46, v68, v46
    v_mfma_f32_16x16x32_bf16 v[56:59], v[152:155], v[48:51], 0
    v_cvt_u32_f32 v42, v42
    v_cvt_u32_f32 v46, v46
    v_cvt_pk_u16_u32 v42, v42, v46
    v_pk_sub_u16 v52, v40, v42 op_sel_hi:[1,0] clamp
    v_pk_sub_u16 v53, v41, v42 op_sel_hi:[1,0] clamp
    v_pk_sub_u16 v54, v44, v42 op_sel:[0,1] clamp
    v_pk_sub_u16 v55, v45, v42 op_sel:[0,1] clamp
    s_cmp_eq_u32 s62, 0
    s_barrier
    ds_read_b64_tr_b16 v[116:117], v20 offset:0
    ds_read_b64_tr_b16 v[118:119], v20 offset:8192
    ds_read_b64_tr_b16 v[120:121], v20 offset:1024
    ds_read_b64_tr_b16 v[122:123], v20 offset:9216
    ds_read_b64_tr_b16 v[124:125], v20 offset:2048
    ds_read_b64_tr_b16 v[126:127], v20 offset:10240
    ds_read_b64_tr_b16 v[128:129], v20 offset:3072
    ds_read_b64_tr_b16 v[130:131], v20 offset:11264
    v_mfma_f32_16x16x32_bf16 v[56:59], v[152:155], v[52:55], v[56:59]
    s_waitcnt lgkmcnt(6)
    v_mfma_f32_16x16x32_bf16 v[84:87], v[116:119], v[48:51], 0
    s_waitcnt lgkmcnt(4)
    v_mfma_f32_16x16x32_bf16 v[88:91], v[120:123], v[48:51], 0
    s_waitcnt lgkmcnt(2)
    v_mfma_f32_16x16x32_bf16 v[92:95], v[124:127], v[48:51], 0
    s_waitcnt lgkmcnt(0)
    v_mfma_f32_16x16x32_bf16 v[96:99], v[128:131], v[48:51], 0
    s_barrier
    ds_read_b64_tr_b16 v[132:133], v20 offset:16384
    ds_read_b64_tr_b16 v[134:135], v20 offset:24576
    ds_read_b64_tr_b16 v[136:137], v20 offset:17408
    ds_read_b64_tr_b16 v[138:139], v20 offset:25600
    ds_read_b64_tr_b16 v[140:141], v20 offset:18432
    ds_read_b64_tr_b16 v[142:143], v20 offset:26624
    s_waitcnt lgkmcnt(4)
    v_mfma_f32_16x16x32_bf16 v[84:87], v[132:135], v[52:55], v[84:87]
    v_rcp_f32 v60, v56
    s_waitcnt lgkmcnt(2)
    v_mfma_f32_16x16x32_bf16 v[88:91], v[136:139], v[52:55], v[88:91]
    v_log_f32 v62, v56
    s_waitcnt lgkmcnt(0)
    v_mfma_f32_16x16x32_bf16 v[92:95], v[140:143], v[52:55], v[92:95]
    v_fmac_f32 v62, 0x3c000000, v68
    s_mov_b64 exec, s[46:47]
    v_pk_mul_f32 v[34:35], v[86:87], v[60:61] op_sel_hi:[1,0]
    v_pk_mul_f32 v[32:33], v[84:85], v[60:61] op_sel_hi:[1,0]
    s_mov_b64 exec, s[40:41]
    v_pk_mul_f32 v[34:35], v[90:91], v[60:61] op_sel_hi:[1,0]
    v_pk_mul_f32 v[32:33], v[88:89], v[60:61] op_sel_hi:[1,0]
    s_mov_b64 exec, s[42:43]
    v_pk_mul_f32 v[34:35], v[94:95], v[60:61] op_sel_hi:[1,0]
    v_pk_mul_f32 v[32:33], v[92:93], v[60:61] op_sel_hi:[1,0]
    s_mov_b64 exec, -1
    s_barrier
    ds_read_b64_tr_b16 v[144:145], v20 offset:19456
    ds_read_b64_tr_b16 v[146:147], v20 offset:27648
    s_waitcnt lgkmcnt(0)
    v_mfma_f32_16x16x32_bf16 v[96:99], v[144:147], v[52:55], v[96:99]
    s_mov_b64 exec, s[54:55]
    s_nop 6
    v_pk_mul_f32 v[34:35], v[98:99], v[60:61] op_sel_hi:[1,0]
    v_pk_mul_f32 v[32:33], v[96:97], v[60:61] op_sel_hi:[1,0]
    s_mov_b64 exec, s[48:49]
    v_perm_b32 v66, v34, v35, s52
    v_perm_b32 v64, v32, v35, s50
    v_perm_b32 v65, v33, v35, s51
    s_cbranch_scc0 L_oslow
    global_store_dwordx4 v14, v[64:67], s[28:29]
    s_mov_b64 exec, 0x0101
    global_store_dwordx2 v13, v[62:63], s[28:29]
L_odone:
    s_barrier
    s_mov_b64 exec, -1
    s_cmp_lt_u32 s31, 28
    s_cbranch_scc1 L_gemv
    global_load_dwordx2 v[72:73], v26, s[28:29] sc1
    global_load_dwordx4 v[100:103], v30, s[28:29] offset:0 sc1
    global_load_dwordx4 v[104:107], v30, s[28:29] offset:1024 sc1
    global_load_dwordx4 v[108:111], v30, s[28:29] offset:2048 sc1
    global_load_dwordx4 v[112:115], v30, s[28:29] offset:3072 sc1
    s_mov_b32 s45, 0
    v_readlane_b32 s37, v62, s33
    s_mov_b32 s36, 0x41c00000
    v_mov_b32 v66, s38
    s_mov_b32 s46, 0x11111111
    s_mov_b32 s47, s46
L_ochk:
    s_waitcnt vmcnt(0)
    v_cmp_ne_u32 s[54:55], s38, v73
    v_cmp_ne_u32 s[40:41], s38, v103
    v_cmp_ne_u32 s[42:43], s38, v107
    v_cmp_ne_u32 s[56:57], s38, v111
    v_cmp_ne_u32 s[58:59], s38, v115
    v_subrev_f32 v56, s37, v72
    s_or_b64 s[34:35], s[40:41], s[42:43]
    s_or_b64 s[48:49], s[56:57], s[58:59]
    s_or_b64 s[34:35], s[34:35], s[54:55]
    s_or_b64 s[34:35], s[34:35], s[48:49]
    s_cbranch_scc1 L_oretry
L_ook:
    v_cmp_nge_f32 vcc, s36, v56
    v_exp_f32 v56, v56
    v_perm_b32 v33, v100, v101, s60
    v_perm_b32 v107, v104, v105, s60
    v_perm_b32 v111, v108, v109, s60
    v_perm_b32 v115, v112, v113, s60
    s_cbranch_vccnz L_truemax
L_wok:
    v_mov_b32_dpp v40, v56 quad_perm:[0,0,0,0] row_mask:0xf bank_mask:0xf
    v_add_f32_dpp v57, v56, v56 quad_perm:[1,0,3,2] row_mask:0xf bank_mask:0xf
    v_mov_b32_dpp v42, v56 quad_perm:[1,1,1,1] row_mask:0xf bank_mask:0xf
    v_perm_b32 v103, v33, v102, s61
    v_add_f32_dpp v57, v57, v57 quad_perm:[2,3,0,1] row_mask:0xf bank_mask:0xf
    v_mov_b32_dpp v44, v56 quad_perm:[2,2,2,2] row_mask:0xf bank_mask:0xf
    v_mov_b32_dpp v46, v56 quad_perm:[3,3,3,3] row_mask:0xf bank_mask:0xf
    v_add_f32_dpp v56, v57, v57 row_ror:8 row_mask:0xf bank_mask:0xf
    v_pk_mul_f32 v[60:61], v[100:101], v[40:41] op_sel_hi:[1,0]
    v_mov_b32 v57, v56
    v_pk_mul_f32 v[62:63], v[102:103], v[40:41] op_sel_hi:[1,0]
    v_pk_fma_f32 v[60:61], v[104:105], v[42:43], v[60:61] op_sel_hi:[1,0,1]
    v_perm_b32 v107, v107, v106, s61
    v_permlane16_swap_b32 v57, v56
    v_add_f32 v56, v56, v57
    v_mov_b32 v57, v56
    v_pk_fma_f32 v[62:63], v[106:107], v[42:43], v[62:63] op_sel_hi:[1,0,1]
    v_pk_fma_f32 v[60:61], v[108:109], v[44:45], v[60:61] op_sel_hi:[1,0,1]
    v_perm_b32 v111, v111, v110, s61
    v_permlane32_swap_b32 v57, v56
    v_pk_fma_f32 v[62:63], v[110:111], v[44:45], v[62:63] op_sel_hi:[1,0,1]
    v_pk_fma_f32 v[60:61], v[112:113], v[46:47], v[60:61] op_sel_hi:[1,0,1]
    v_perm_b32 v115, v115, v114, s61
    v_pk_fma_f32 v[62:63], v[114:115], v[46:47], v[62:63] op_sel_hi:[1,0,1]
    v_add_f32 v56, v56, v57
    s_cmp_eq_u32 s62, 0
    v_permlane32_swap_b32 v60, v62
    v_permlane32_swap_b32 v61, v63
    v_pk_add_f32 v[60:61], v[60:61], v[62:63]
    v_rcp_f32 v56, v56
    s_nop 0
    v_permlane16_swap_b32 v60, v61
    v_add_f32 v60, v60, v61
    s_nop 1
    v_add_f32_dpp v60, v60, v60 row_ror:8 row_mask:0xf bank_mask:0xf
    v_mul_f32 v61, v60, v56
    v_mul_f32 v60, v60, v56
    s_nop 1
    v_permlane16_swap_b32 v61, v60
    v_cvt_pk_bf16_f32 v64, v61, v60
    v_cvt_pk_bf16_f32 v65, v61, v60
    s_nop 1
    v_permlane32_swap_b32 v64, v65
    s_mov_b64 exec, 0xff
    s_cbranch_scc0 L_fslow
    global_store_dwordx4 v28, v[64:67], s[28:29]
    s_barrier
    s_endpgm
L_oretry:
    global_load_dwordx2 v[72:73], v26, s[28:29] sc1
    s_or_b64 exec, s[40:41], 1
    global_load_dwordx4 v[100:103], v30, s[28:29] offset:0 sc1
    s_or_b64 exec, s[42:43], 1
    global_load_dwordx4 v[104:107], v30, s[28:29] offset:1024 sc1
    s_or_b64 exec, s[56:57], 1
    global_load_dwordx4 v[108:111], v30, s[28:29] offset:2048 sc1
    s_or_b64 exec, s[58:59], 1
    global_load_dwordx4 v[112:115], v30, s[28:29] offset:3072 sc1
L_onext:
    s_mov_b64 exec, -1
    s_add_u32 s45, s45, 1
    s_cmp_ge_u32 s45, 32768
    s_cbranch_scc0 L_ochk
    s_waitcnt vmcnt(0)
    s_branch L_ook
L_omany:
    s_branch L_onext
L_truemax:
    v_max_f32_dpp v56, v72, v72 quad_perm:[1,0,3,2] row_mask:0xf bank_mask:0xf
    s_nop 1
    v_max_f32_dpp v56, v56, v56 quad_perm:[2,3,0,1] row_mask:0xf bank_mask:0xf
    s_nop 1
    v_max_f32_dpp v56, v56, v56 row_ror:8 row_mask:0xf bank_mask:0xf
    v_mov_b32 v57, v56
    s_nop 1
    v_permlane16_swap_b32 v57, v56
    v_max_f32 v56, v56, v57
    v_mov_b32 v57, v56
    s_nop 1
    v_permlane32_swap_b32 v57, v56
    v_max_f32 v56, v56, v57
    v_sub_f32 v56, v72, v56
    v_exp_f32 v56, v56
    s_nop 1
    s_branch L_wok
L_fslow:
    global_store_dwordx4 v28, v[64:67], s[28:29] sc1
    s_barrier
    s_endpgm
L_gemv:
    s_cmp_eq_u32 s63, 0
    s_cbranch_scc1 L_noffn
    ds_read_b128 v[72:75], v6
    s_mov_b32 exec_lo, 0x0fff0fff
    s_mov_b32 exec_hi, 0x0fff0fff
    ds_read_b128 v[76:79], v6 offset:1024
    s_mov_b64 exec, -1
    s_waitcnt lgkmcnt(0)
L_hchk:
    v_cmp_ne_u32 vcc, s38, v75
    v_cmp_ne_u32 s[54:55], s38, v79
    v_perm_b32 v82, v72, v73, s60
    v_perm_b32 v83, v76, v77, s60
    s_or_b64 vcc, vcc, s[54:55]
    s_cbranch_scc1 L_hretry
L_hok:
    v_perm_b32 v75, v82, v74, s61
    v_perm_b32 v79, v83, v78, s61
    v_pk_add_f32 v[72:73], v[72:73], v[76:77]
    v_pk_add_f32 v[74:75], v[74:75], v[78:79]
    v_lshlrev_b32 v76, 16, v80
    v_add_f32_dpp v72, v72, v72 row_ror:4 row_mask:0xf bank_mask:0xf
    v_add_f32_dpp v73, v73, v73 row_ror:4 row_mask:0xf bank_mask:0xf
    v_add_f32_dpp v74, v74, v74 row_ror:4 row_mask:0xf bank_mask:0xf
    v_add_f32_dpp v75, v75, v75 row_ror:4 row_mask:0xf bank_mask:0xf
    v_add_f32_dpp v72, v72, v72 row_ror:8 row_mask:0xf bank_mask:0xf
    v_add_f32_dpp v73, v73, v73 row_ror:8 row_mask:0xf bank_mask:0xf
    v_add_f32_dpp v74, v74, v74 row_ror:8 row_mask:0xf bank_mask:0xf
    v_add_f32_dpp v75, v75, v75 row_ror:8 row_mask:0xf bank_mask:0xf
    v_cvt_pk_bf16_f32 v82, v72, v73
    v_cvt_pk_bf16_f32 v83, v74, v75
    v_lshlrev_b32 v72, 16, v82
    v_and_b32 v73, 0xffff0000, v82
    v_lshlrev_b32 v74, 16, v83
    v_and_b32 v75, 0xffff0000, v83
    v_and_b32 v77, 0xffff0000, v80
    v_lshlrev_b32 v78, 16, v81
    v_and_b32 v79, 0xffff0000, v81
    v_pk_add_f32 v[72:73], v[72:73], v[76:77]
    v_pk_add_f32 v[74:75], v[74:75], v[78:79]
    v_cvt_pk_bf16_f32 v82, v72, v73
    v_cvt_pk_bf16_f32 v83, v74, v75
    v_lshlrev_b32 v72, 16, v82
    v_and_b32 v73, 0xffff0000, v82
    v_lshlrev_b32 v74, 16, v83
    v_and_b32 v75, 0xffff0000, v83
    v_mov_b32 v80, 0xc0135761
    v_pk_mul_f32 v[76:77], v[72:73], v[72:73]
    v_pk_mul_f32 v[78:79], v[74:75], v[74:75]
    v_fmamk_f32 v76, v76, 0xbdd2d3e8, v80
    v_fmamk_f32 v77, v77, 0xbdd2d3e8, v80
    v_fmamk_f32 v78, v78, 0xbdd2d3e8, v80
    v_fmamk_f32 v79, v79, 0xbdd2d3e8, v80
    v_pk_mul_f32 v[76:77], v[76:77], v[72:73]
    v_pk_mul_f32 v[78:79], v[78:79], v[74:75]
    v_exp_f32 v76, v76
    v_exp_f32 v77, v77
    v_exp_f32 v78, v78
    v_exp_f32 v79, v79
    v_add_f32 v76, 1.0, v76
    v_add_f32 v77, 1.0, v77
    v_add_f32 v78, 1.0, v78
    v_add_f32 v79, 1.0, v79
    v_rcp_f32 v76, v76
    v_rcp_f32 v77, v77
    v_rcp_f32 v78, v78
    v_rcp_f32 v79, v79
    v_pk_mul_f32 v[76:77], v[76:77], v[72:73]
    v_pk_mul_f32 v[78:79], v[78:79], v[74:75]
    v_cvt_pk_bf16_f32 v82, v76, v77
    v_cvt_pk_bf16_f32 v83, v78, v79
    s_barrier
    ds_read_b64_tr_b16 v[116:117], v24 offset:25600
    ds_read_b64_tr_b16 v[118:119], v24 offset:27648
    ds_read_b64_tr_b16 v[120:121], v24 offset:29696
    ds_read_b64_tr_b16 v[122:123], v24 offset:31744
    v_mov_b64_dpp v[72:73], v[82:83] row_newbcast:0 row_mask:0xf bank_mask:0xf
    v_mov_b64_dpp v[74:75], v[82:83] row_newbcast:1 row_mask:0xf bank_mask:0xf
    v_mov_b64_dpp v[76:77], v[82:83] row_newbcast:2 row_mask:0xf bank_mask:0xf
    v_mov_b64_dpp v[78:79], v[82:83] row_newbcast:3 row_mask:0xf bank_mask:0xf
    s_waitcnt lgkmcnt(0)
    v_mfma_f32_16x16x32_bf16 v[48:51], v[116:119], v[72:75], 0
    v_mfma_f32_16x16x32_bf16 v[48:51], v[120:123], v[76:79], v[48:51]
L_ffnd:
    s_mov_b32 s45, 0
    v_mov_b32 v55, s38
    s_barrier
    global_load_dwordx4 v[56:59], v28, s[28:29] sc1
    ds_read_b64_tr_b16 v[124:125], v24 offset:33792
    ds_read_b64_tr_b16 v[126:127], v24 offset:35840
    ds_read_b64_tr_b16 v[128:129], v24 offset:37888
    ds_read_b64_tr_b16 v[130:131], v24 offset:39936
    ds_read_b64_tr_b16 v[132:133], v24 offset:41984
    ds_read_b64_tr_b16 v[134:135], v24 offset:44032
    s_barrier
    ds_read_b64_tr_b16 v[136:137], v24 offset:46080
    ds_read_b64_tr_b16 v[138:139], v24 offset:48128
    s_waitcnt vmcnt(0)
    v_cmp_ne_u32 vcc, s38, v58
    v_mov_b64_dpp v[84:85], v[56:57] row_newbcast:0 row_mask:0xf bank_mask:0xf
    v_mov_b64_dpp v[86:87], v[56:57] row_newbcast:1 row_mask:0xf bank_mask:0xf
    v_mov_b64_dpp v[88:89], v[56:57] row_newbcast:2 row_mask:0xf bank_mask:0xf
    v_mov_b64_dpp v[90:91], v[56:57] row_newbcast:3 row_mask:0xf bank_mask:0xf
    v_mov_b64 v[108:109], v[56:57]
    s_cbranch_vccnz L_fretry
L_fok:
    s_waitcnt lgkmcnt(0)
    v_mfma_f32_16x16x32_bf16 v[48:51], v[124:127], v[84:87], v[48:51]
    v_mov_b64_dpp v[92:93], v[108:109] row_newbcast:4 row_mask:0xf bank_mask:0xf
    v_mov_b64_dpp v[94:95], v[108:109] row_newbcast:5 row_mask:0xf bank_mask:0xf
    v_mfma_f32_16x16x32_bf16 v[48:51], v[128:131], v[88:91], v[48:51]
    v_mov_b64_dpp v[96:97], v[108:109] row_newbcast:6 row_mask:0xf bank_mask:0xf
    v_mov_b64_dpp v[98:99], v[108:109] row_newbcast:7 row_mask:0xf bank_mask:0xf
    v_mfma_f32_16x16x32_bf16 v[48:51], v[132:135], v[92:95], v[48:51]
    s_nop 0
    v_mfma_f32_16x16x32_bf16 v[48:51], v[136:139], v[96:99], v[48:51]
    s_mov_b32 exec_lo, 0x00010001
    s_mov_b32 exec_hi, 0x00010001
    s_nop 5
    v_perm_b32 v52, v48, v51, s50
    v_perm_b32 v53, v49, v51, s51
    v_perm_b32 v54, v50, v51, s52
    global_store_dwordx4 v29, v[52:55], s[28:29] sc1
    global_store_dwordx4 v30, v[52:55], s[28:29] sc1
    s_endpgm
L_fretry:
    global_load_dwordx4 v[56:59], v28, s[28:29] sc1
L_floop:
    global_load_dwordx4 v[68:71], v28, s[28:29] sc1
    s_waitcnt vmcnt(1)
    v_cmp_ne_u32 vcc, s38, v58
    v_mov_b64_dpp v[84:85], v[56:57] row_newbcast:0 row_mask:0xf bank_mask:0xf
    v_mov_b64_dpp v[86:87], v[56:57] row_newbcast:1 row_mask:0xf bank_mask:0xf
    v_mov_b64_dpp v[88:89], v[56:57] row_newbcast:2 row_mask:0xf bank_mask:0xf
    v_mov_b64_dpp v[90:91], v[56:57] row_newbcast:3 row_mask:0xf bank_mask:0xf
    v_mov_b64 v[108:109], v[56:57]
    s_cbranch_vccz L_fok
    global_load_dwordx4 v[56:59], v28, s[28:29] sc1
    s_waitcnt vmcnt(1)
    v_cmp_ne_u32 vcc, s38, v70
    v_mov_b64_dpp v[84:85], v[68:69] row_newbcast:0 row_mask:0xf bank_mask:0xf
    v_mov_b64_dpp v[86:87], v[68:69] row_newbcast:1 row_mask:0xf bank_mask:0xf
    v_mov_b64_dpp v[88:89], v[68:69] row_newbcast:2 row_mask:0xf bank_mask:0xf
    v_mov_b64_dpp v[90:91], v[68:69] row_newbcast:3 row_mask:0xf bank_mask:0xf
    v_mov_b64 v[108:109], v[68:69]
    s_cbranch_vccz L_fok
    s_add_u32 s45, s45, 1
    s_cmp_ge_u32 s45, 32768
    s_cbranch_scc0 L_floop
    s_branch L_fok
L_hretry:
    s_add_u32 s45, s45, 1
    s_cmp_ge_u32 s45, 32768
    s_cbranch_scc1 L_hok
    global_load_dwordx4 v[72:75], v26, s[28:29] sc1
    s_mov_b32 exec_lo, 0x0fff0fff
    s_mov_b32 exec_hi, 0x0fff0fff
    global_load_dwordx4 v[76:79], v26, s[28:29] offset:1024 sc1
    s_mov_b64 exec, -1
    s_waitcnt vmcnt(0)
    s_branch L_hchk
L_noffn:
    v_mov_b32 v48, 0
    v_mov_b32 v49, 0
    v_mov_b32 v50, 0
    v_mov_b32 v51, 0
    s_branch L_ffnd
L_oslow:
    global_store_dwordx4 v14, v[64:67], s[28:29] sc1
    s_mov_b64 exec, 0x0101
    global_store_dwordx2 v13, v[62:63], s[28:29] sc1
    s_branch L_odone
L_qslow:
    v_subrev_u32 v67, s38, v67
    v_subrev_u32 v71, s38, v71
    v_or_b32 v67, v67, v71
    v_cmp_lt_u32 s[58:59], 15, v67
    s_add_u32 s45, s45, 1
    s_cmp_eq_u64 s[58:59], 0
    s_cbranch_scc1 L_repub
    s_cmp_eq_u32 s45, 3
    s_cbranch_scc0 L_qagain
L_repub:
    v_mov_b32 v67, s57
    v_mov_b32 v71, s56
    v_cmp_gt_u32 vcc, 16, v0
    s_cmp_eq_u32 s63, 0
    s_cselect_b32 s34, 0xffff, -1
    s_mov_b32 s35, 0
    v_cndmask_b32 v67, v67, v71, vcc
    v_lshl_add_u32 v67, v1, 4, v67
    s_mov_b32 s40, 0
    s_mov_b64 exec, s[34:35]
L_repub1:
    global_load_dwordx4 v[156:159], v67, s[28:29] sc1
    s_add_u32 s40, s40, 1
    s_cmp_ge_u32 s40, 32768
    s_waitcnt vmcnt(0)
    s_cbranch_scc1 L_repub2
    v_subrev_u32 v71, s38, v159
    v_cmp_lt_u32 vcc, 15, v71
    s_cbranch_vccnz L_repub1
L_repub2:
    global_store_dwordx4 v67, v[156:159], s[28:29] sc1
    s_mov_b64 exec, -1
    s_waitcnt vmcnt(0)
    v_mov_b32 v67, 1
    s_cmp_eq_u64 s[58:59], 0
    s_cbranch_scc1 L_qok
L_qagain:
    v_mov_b32 v67, 1
    s_cmp_ge_u32 s45, 32768
    s_cbranch_scc1 L_qok
    global_load_dwordx4 v[64:67], v18, s[28:29] sc1
    global_load_dwordx4 v[68:71], v19, s[28:29] sc1
    s_waitcnt vmcnt(0)
    s_branch L_qchk
L_end:
    s_endpgm
.fill 1024, 4, 0xbf800000
.section .rodata,"a"
.p2align 6
.amdhsa_kernel parallel_sum__sliding_block_cached__dense_activation_gelu__decode_kernel
  .amdhsa_next_free_vgpr 168
  .amdhsa_next_free_sgpr 96
  .amdhsa_accum_offset 168
  .amdhsa_group_segment_fixed_size 0
  .amdhsa_kernarg_size 104
  .amdhsa_user_sgpr_count 2
  .amdhsa_user_sgpr_kernarg_segment_ptr 1
  .amdhsa_system_sgpr_workgroup_id_x 1
  .amdhsa_float_denorm_mode_32 3
.end_amdhsa_kernel
```
